```python
import torch

def _softmax(x, axis=-1):
    return torch.softmax(x, dim=axis)
def _gelu(x):
    return torch.nn.functional.gelu(x, approximate="tanh")
def _silu(x):
    return torch.nn.functional.silu(x)
def _sigmoid(x):
    return torch.sigmoid(x)
def _layernorm(x, axis=-1, eps=1e-5):
    m = x.mean(dim=axis, keepdim=True)
    v = x.var(dim=axis, keepdim=True, unbiased=False)
    return (x - m) / torch.sqrt(v + eps)
def _scatter_add(tgt, idx, src, axis=0):
    return tgt.clone().index_add_(axis, idx, src)
def _segment_sum(src, seg, n):
    out = torch.zeros((n,) + src.shape[1:], dtype=src.dtype)
    return out.index_add_(0, seg, src)
def _pad(x, pw):
    flat = tuple(v for pair in reversed(pw) for v in pair)
    return torch.nn.functional.pad(x, flat)

kernel_name = 'standalone__sequential_behavior_din__recsys'

def setup_inputs():

    _w = (lambda a: (lambda t: t.to(torch.bfloat16) if t.is_floating_point() else t)(torch.as_tensor(a)))
    B, L, D = 4096, 200, 128
    H = D
    return {
        "target": _w((lambda *s: torch.randn(*s, dtype=torch.bfloat16) * 1.6)(B, D)),
        "hist": _w((lambda *s: torch.randn(*s, dtype=torch.bfloat16) * 1.6)(B, L, D)),
        "mask": _w((lambda lo, hi, *s: torch.randint(lo, hi, s))(0, 2, B, L).to(float)),
        "w1": _w((lambda *s: torch.randn(*s, dtype=torch.bfloat16) * 1.6)(4 * D, H) * (4 * D) ** -0.5),
        "b1": _w((lambda *s: torch.randn(*s, dtype=torch.bfloat16) * 3.2)(H) * 0.1),
        "w2": _w((lambda *s: torch.randn(*s, dtype=torch.bfloat16) * 0.05)(H, 1) * H ** -0.5),
        "b2": _w((lambda *s: torch.randn(*s, dtype=torch.bfloat16) * 0.05)(1) * 0.1),
    }

def reference(target, hist, mask, w1, b1, w2, b2):
    L = hist.shape[1]
    tgt = (lambda x, n, axis: torch.repeat_interleave(x, n, dim=axis))(target[:, None, :], L, axis=1)
    feat = torch.concatenate([hist, tgt, hist - tgt, hist * tgt], axis=-1)
    h = _sigmoid(feat @ w1 + b1)
    scores = (h @ w2 + b2)[..., 0] * mask
    return torch.einsum('bl,bld->bd', scores, hist)
```

```asm
; @launch grid=(256,1,1) block=(512,1,1) lds=160000
.amdgcn_target "amdgcn-amd-amdhsa--gfx950"
.text
.globl standalone__sequential_behavior_din__recsys_kernel
.p2align 8
.type standalone__sequential_behavior_din__recsys_kernel,@function
standalone__sequential_behavior_din__recsys_kernel:
    s_cmp_ge_u32 s2, 256
    s_cbranch_scc1 L_END
    s_load_dwordx16 s[64:79], s[0:1], 0
    v_lshrrev_b32 v1, 6, v0
    v_and_b32 v0, 63, v0
    v_readfirstlane_b32 s36, v1
    v_and_b32 v1, 15, v0
    v_lshrrev_b32 v2, 4, v0
    v_lshlrev_b32 v3, 1, v0
    v_mov_b32 v124, 0x100000
    v_lshlrev_b32 v121, 4, v0
    v_cmp_gt_u32 vcc, 4, v0
    s_lshr_b32 s46, s2, 3
    s_lshl_b32 s46, s46, 3
    s_add_u32 s46, s46, s36
    s_and_b32 s46, s46, 0xff
    s_lshl_b32 s46, s46, 9
    v_lshlrev_b32 v127, 7, v0
    v_add_u32 v127, s46, v127
    v_cndmask_b32 v127, v124, v127, vcc
    s_lshl_b32 s46, s36, 12
    v_add_u32 v126, s46, v121
    s_lshl_b32 s46, s2, 4
    s_lshl_b32 s47, s36, 1
    s_add_u32 s42, s46, s47
    s_mul_i32 s37, s36, 8256
    s_add_u32 s37, s37, 65664
    s_mul_i32 s38, s42, 400
    s_mul_i32 s39, s42, 51200
    s_lshl_b32 s40, s42, 8
    s_lshl_b32 s41, s2, 12
    s_and_b32 s46, s36, 1
    s_lshl_b32 s46, s46, 1
    v_add_u32 v125, s46, v2
    v_lshlrev_b32 v125, 2, v125
    v_xor_b32 v125, v1, v125
    v_lshlrev_b32 v125, 4, v125
    v_lshl_add_u32 v125, v2, 8, v125
    s_lshl_b32 s47, s36, 9
    v_add_u32 v125, s47, v125
    s_lshr_b32 s52, s36, 1
    s_lshl_b32 s53, s52, 10
    s_lshr_b32 s52, s52, 1
    s_lshl_b32 s52, s52, 5
    s_add_u32 s53, s53, s52
    s_lshl_b32 s46, s46, 8
    s_add_u32 s53, s53, s46
    s_add_u32 s45, s53, 155776
    v_lshlrev_b32 v111, 2, v0
    v_mov_b32 v112, 0
    s_lshl_b32 s46, s36, 5
    v_lshlrev_b32 v113, 3, v2
    v_add_u32 v113, s46, v113
    v_and_b32 v110, 1, v0
    v_mul_u32_u24 v110, 51200, v110
    s_mov_b32 s14, 131072
    s_mov_b32 s15, 0x00020000
    s_movk_i32 s10, 800
    s_mov_b32 s11, 0x00020000
    s_movk_i32 s18, 4096
    s_mov_b32 s19, 0x00020000
    s_movk_i32 s26, 256
    s_mov_b32 s27, 0x00020000
    s_mov_b32 s30, 2
    s_mov_b32 s31, 0x00020000
    s_movk_i32 s22, 256
    s_mov_b32 s23, 0x00020000
    s_mov_b32 s6, 102400
    s_mov_b32 s7, 0x00020000
    s_mov_b32 m0, s45
    s_waitcnt lgkmcnt(0)
    s_mov_b32 s12, s70
    s_mov_b32 s13, s71
    buffer_load_dword v127, v127, s[12:15], 0 offen
    s_cmp_lg_u32 s36, 0
    s_cbranch_scc1 L_NOW2
    s_mov_b32 s24, s74
    s_mov_b32 s25, s75
    s_mov_b32 s28, s76
    s_mov_b32 s29, s77
    buffer_load_dword v106, v111, s[24:27], 0 offen
    buffer_load_ushort v107, v112, s[28:31], 0 offen
L_NOW2:
    s_add_u32 s16, s64, s41
    s_addc_u32 s17, s65, 0
    s_mov_b32 exec_hi, 0
    buffer_load_dwordx4 v125, s[16:19], 0 offen lds
    s_mov_b32 exec_hi, -1
    s_add_u32 s8, s68, s38
    s_addc_u32 s9, s69, 0
    s_mov_b32 m0, s37
    s_mov_b32 s20, s72
    buffer_load_dwordx4 v121, s[8:11], 0 offen lds
    s_mov_b32 s21, s73
    buffer_load_dwordx2 v[104:105], v113, s[20:23], 0 offen
    s_add_u32 s4, s66, s39
    s_addc_u32 s5, s67, 0
    buffer_load_dword v110, v110, s[4:7], 0 offen
    s_add_u32 s32, s78, s40
    s_addc_u32 s33, s79, 0
    s_movk_i32 s34, 512
    s_mov_b32 s35, 0x00020000
    v_add_u32 v124, s37, v3
    v_mov_b32 v99, 0
    v_mov_b32 v103, 0
    v_lshlrev_b32 v121, 2, v2
    v_xor_b32 v15, v1, v121
    v_lshlrev_b32 v15, 4, v15
    v_lshrrev_b32 v114, 2, v1
    v_and_b32 v115, 3, v1
    v_and_b32 v76, 1, v114
    v_lshlrev_b32 v76, 4, v76
    v_mov_b32 v77, 0x3f80
    v_lshlrev_b32 v77, v76, v77
    v_cmp_eq_u32 vcc, v115, v2
    v_mov_b32 v80, 0
    v_mov_b32 v81, 0
    v_cndmask_b32 v77, 0, v77, vcc
    v_cmp_gt_u32 vcc, 2, v114
    v_mov_b32 v84, 0
    v_mov_b32 v85, 0
    v_cndmask_b32 v82, 0, v77, vcc
    v_cndmask_b32 v83, v77, 0, vcc
    v_mov_b32 v86, 0
    v_mov_b32 v87, 0
    v_lshlrev_b32 v76, 8, v82
    v_and_b32 v76, 0x80008000, v76
    v_or_b32 v88, v82, v76
    v_lshlrev_b32 v76, 8, v83
    v_and_b32 v76, 0x80008000, v76
    v_or_b32 v89, v83, v76
    v_mov_b32 v90, 0
    v_mov_b32 v91, 0
    v_lshrrev_b32 v76, 1, v1
    v_and_b32 v77, 1, v1
    v_lshlrev_b32 v77, 7, v77
    v_lshl_add_u32 v77, v2, 4, v77
    s_lshr_b32 s46, s36, 1
    s_lshl_b32 s46, s46, 11
    s_and_b32 s47, s36, 1
    s_lshl_b32 s52, s47, 8
    s_add_u32 s52, s52, s46
    s_movk_i32 s53, 8208
    v_mad_u32_u24 v108, v76, s53, v77
    v_add_u32 v108, s52, v108
    v_xor_b32 v78, v2, v114
    v_and_b32 v77, 1, v1
    v_lshlrev_b32 v77, 7, v77
    v_lshl_add_u32 v77, v78, 4, v77
    s_movk_i32 s53, 8256
    v_mad_u32_u24 v109, v76, s53, v77
    s_lshl_b32 s52, s36, 9
    s_add_u32 s52, s52, 69792
    v_add_u32 v109, s52, v109
    s_mov_b32 s100, 0xbfb8aa3b
    s_mov_b32 s101, 0xbfb8aa3b
    s_mul_i32 s64, s36, 1920
    s_add_u32 s64, s64, 140160
    v_lshlrev_b32 v120, 4, v0
    v_add_u32 v120, s64, v120
    v_mov_b32 v64, -1
    v_mov_b32 v65, -1
    v_mov_b32 v66, -1
    v_mov_b32 v67, -1
    ds_write_b128 v120, v[64:67]
    v_mov_b32 v68, 0
    v_mov_b32 v69, 0
    v_mov_b32 v70, 0
    v_mov_b32 v71, 0
    ds_write_b128 v120, v[68:71] offset:896
    v_lshlrev_b32 v12, 1, v2
    v_add_u32 v12, s64, v12
    s_add_u32 s65, s64, 896
    v_lshlrev_b32 v13, 3, v2
    v_add_u32 v13, s65, v13
    s_mul_i32 s46, s36, 1056
    s_add_u32 s46, s46, 131712
    v_lshlrev_b32 v14, 4, v2
    v_add_u32 v14, s46, v14
    v_lshlrev_b32 v121, 10, v114
    v_lshl_add_u32 v121, v115, 8, v121
    v_lshrrev_b32 v122, 3, v1
    v_lshl_add_u32 v121, v122, 5, v121
    v_lshl_add_u32 v121, v2, 4, v121
    v_add_u32 v121, s37, v121
    s_sub_u32 s46, 155776, s37
    v_xor_b32 v122, 0, v115
    v_lshl_add_u32 v20, v122, 6, v121
    v_add_u32 v92, s46, v20
    v_xor_b32 v122, 1, v115
    v_lshl_add_u32 v21, v122, 6, v121
    v_add_u32 v93, s46, v21
    v_xor_b32 v122, 2, v115
    v_lshl_add_u32 v22, v122, 6, v121
    v_add_u32 v94, s46, v22
    v_xor_b32 v122, 3, v115
    v_lshl_add_u32 v23, v122, 6, v121
    v_add_u32 v95, s46, v23
    v_lshrrev_b32 v122, 1, v115
    v_lshl_add_u32 v122, v2, 1, v122
    v_lshlrev_b32 v123, 2, v114
    v_xor_b32 v122, v122, v123
    v_and_b32 v123, 1, v115
    v_lshlrev_b32 v123, 3, v123
    v_lshl_add_u32 v123, v114, 8, v123
    v_add_u32 v123, s37, v123
    v_lshl_add_u32 v16, v122, 4, v123
    v_xor_b32 v122, 8, v122
    v_lshl_add_u32 v17, v122, 4, v123
    s_and_b32 s46, s36, 1
    s_lshl_b32 s46, s46, 7
    s_add_u32 s52, s45, s46
    s_sub_u32 s53, s45, s46
    v_lshlrev_b32 v122, 1, v115
    v_lshl_add_u32 v122, v114, 4, v122
    v_add_u32 v18, s52, v122
    v_add_u32 v19, s53, v122
    v_add_u32 v116, 0, v0
    v_add_u32 v117, 64, v0
    v_add_u32 v118, 128, v0
    v_add_u32 v119, 192, v0
    v_add_u32 v120, 200, v0
    v_add_u32 v121, 264, v0
    v_add_u32 v122, 328, v0
    v_add_u32 v123, 392, v0
    v_lshrrev_b32 v64, 1, v1
    v_and_b32 v65, 1, v2
    v_lshlrev_b32 v65, 2, v65
    v_sub_u32 v64, v64, v65
    v_and_b32 v65, 1, v1
    v_lshlrev_b32 v65, 4, v65
    v_mov_b32 v66, 0x0d0c
    v_lshlrev_b32 v66, v65, v66
    v_cmp_eq_u32 vcc, 0, v64
    v_mov_b32 v68, 0x0c0c0c0c
    s_nop 0
    v_cndmask_b32 v67, 0, v66, vcc
    v_xor_b32 v4, v68, v67
    v_cmp_eq_u32 vcc, 1, v64
    v_mov_b32 v68, 0x0c0c0c0c
    s_nop 0
    v_cndmask_b32 v67, 0, v66, vcc
    v_xor_b32 v5, v68, v67
    v_cmp_eq_u32 vcc, 2, v64
    v_mov_b32 v68, 0x0c0c0c0c
    s_nop 0
    v_cndmask_b32 v67, 0, v66, vcc
    v_xor_b32 v6, v68, v67
    v_cmp_eq_u32 vcc, 3, v64
    v_mov_b32 v68, 0x0c0c0c0c
    s_nop 0
    v_cndmask_b32 v67, 0, v66, vcc
    v_xor_b32 v7, v68, v67
    s_waitcnt vmcnt(2)
    ds_read_u16_d16_hi v96, v124 offset:0
    ds_read_u16_d16_hi v97, v124 offset:128
    ds_read_u16_d16_hi v98, v124 offset:256
    ds_read_u16_d16_hi v100, v124 offset:400
    ds_read_u16_d16_hi v101, v124 offset:528
    ds_read_u16_d16_hi v102, v124 offset:656
    s_mov_b64 exec, 0xff
    ds_read_u16_d16_hi v99, v124 offset:384
    ds_read_u16_d16_hi v103, v124 offset:784
    s_mov_b64 exec, -1
    s_mov_b32 s46, 98304
    buffer_load_dwordx4 v[176:179], v126, s[12:15], s46 offen offset:0
    buffer_load_dwordx4 v[180:183], v126, s[12:15], s46 offen offset:1024
    buffer_load_dwordx4 v[184:187], v126, s[12:15], s46 offen offset:2048
    buffer_load_dwordx4 v[188:191], v126, s[12:15], s46 offen offset:3072
    s_waitcnt lgkmcnt(0)
    v_cmp_neq_f32 s[84:85], 0, v96
    v_cmp_neq_f32 s[86:87], 0, v97
    v_cmp_neq_f32 s[88:89], 0, v98
    v_cmp_neq_f32 s[90:91], 0, v99
    v_cmp_neq_f32 s[92:93], 0, v100
    v_cmp_neq_f32 s[94:95], 0, v101
    v_cmp_neq_f32 s[96:97], 0, v102
    v_cmp_neq_f32 s[98:99], 0, v103
    v_mbcnt_lo_u32_b32 v64, s84, 0
    v_mbcnt_hi_u32_b32 v64, s85, v64
    v_mbcnt_lo_u32_b32 v65, s86, 0
    v_mbcnt_hi_u32_b32 v65, s87, v65
    v_mbcnt_lo_u32_b32 v66, s88, 0
    v_mbcnt_hi_u32_b32 v66, s89, v66
    v_mbcnt_lo_u32_b32 v67, s90, 0
    v_mbcnt_hi_u32_b32 v67, s91, v67
    v_mbcnt_lo_u32_b32 v68, s92, 0
    v_mbcnt_hi_u32_b32 v68, s93, v68
    v_mbcnt_lo_u32_b32 v69, s94, 0
    v_mbcnt_hi_u32_b32 v69, s95, v69
    v_mbcnt_lo_u32_b32 v70, s96, 0
    v_mbcnt_hi_u32_b32 v70, s97, v70
    v_mbcnt_lo_u32_b32 v71, s98, 0
    v_mbcnt_hi_u32_b32 v71, s99, v71
    s_mov_b32 s66, s64
    s_bcnt1_i32_b64 s46, s[84:85]
    s_lshl1_add_u32 s67, s46, s66
    s_bcnt1_i32_b64 s46, s[86:87]
    s_lshl1_add_u32 s68, s46, s67
    s_bcnt1_i32_b64 s46, s[88:89]
    s_lshl1_add_u32 s69, s46, s68
    s_bcnt1_i32_b64 s46, s[90:91]
    s_lshl1_add_u32 s47, s46, s69
    s_sub_u32 s47, s47, s66
    s_add_u32 s47, s47, 31
    s_lshr_b32 s39, s47, 5
    s_max_u32 s39, s39, 1
    s_lshl_b32 s47, s39, 5
    s_add_u32 s70, s47, s66
    s_bcnt1_i32_b64 s46, s[92:93]
    s_lshl1_add_u32 s71, s46, s70
    s_bcnt1_i32_b64 s46, s[94:95]
    s_lshl1_add_u32 s72, s46, s71
    s_bcnt1_i32_b64 s46, s[96:97]
    s_lshl1_add_u32 s73, s46, s72
    s_bcnt1_i32_b64 s46, s[98:99]
    s_lshl1_add_u32 s47, s46, s73
    s_sub_u32 s47, s47, s70
    s_add_u32 s47, s47, 31
    s_lshr_b32 s40, s47, 5
    s_max_u32 s40, s40, 1
    s_mov_b32 s46, 65536
    buffer_load_dwordx4 v[144:147], v126, s[12:15], s46 offen offset:0
    buffer_load_dwordx4 v[148:151], v126, s[12:15], s46 offen offset:1024
    buffer_load_dwordx4 v[152:155], v126, s[12:15], s46 offen offset:2048
    buffer_load_dwordx4 v[156:159], v126, s[12:15], s46 offen offset:3072
    v_lshl_add_u32 v72, v64, 1, s66
    v_lshl_add_u32 v73, v65, 1, s67
    v_lshl_add_u32 v74, v66, 1, s68
    v_lshl_add_u32 v75, v67, 1, s69
    v_lshl_add_u32 v76, v68, 1, s70
    v_lshl_add_u32 v77, v69, 1, s71
    v_lshl_add_u32 v78, v70, 1, s72
    v_lshl_add_u32 v79, v71, 1, s73
    s_mov_b64 exec, s[84:85]
    ds_write_b16 v72, v116
    ds_write_b16_d16_hi v72, v96 offset:896
    s_mov_b64 exec, s[86:87]
    ds_write_b16 v73, v117
    ds_write_b16_d16_hi v73, v97 offset:896
    s_mov_b64 exec, s[88:89]
    ds_write_b16 v74, v118
    ds_write_b16_d16_hi v74, v98 offset:896
    s_mov_b64 exec, s[90:91]
    ds_write_b16 v75, v119
    ds_write_b16_d16_hi v75, v99 offset:896
    s_mov_b64 exec, s[92:93]
    ds_write_b16 v76, v120
    ds_write_b16_d16_hi v76, v100 offset:896
    s_mov_b64 exec, s[94:95]
    ds_write_b16 v77, v121
    ds_write_b16_d16_hi v77, v101 offset:896
    s_mov_b64 exec, s[96:97]
    ds_write_b16 v78, v122
    ds_write_b16_d16_hi v78, v102 offset:896
    s_mov_b64 exec, s[98:99]
    ds_write_b16 v79, v123
    ds_write_b16_d16_hi v79, v103 offset:896
    s_mov_b64 exec, -1
    ds_read_u16 v24, v12 offset:0
    ds_read_u16 v25, v12 offset:8
    ds_read_u16 v26, v12 offset:16
    ds_read_u16 v27, v12 offset:24
    ds_read_u16 v44, v12 offset:32
    ds_read_u16 v45, v12 offset:40
    ds_read_u16 v46, v12 offset:48
    ds_read_u16 v47, v12 offset:56
    ds_read_u16 v36, v18 offset:0
    ds_read_u16 v32, v18 offset:8
    ds_read_u16 v37, v18 offset:64
    ds_read_u16 v33, v18 offset:72
    ds_read_u16 v38, v19 offset:128
    ds_read_u16 v34, v19 offset:136
    ds_read_u16 v39, v19 offset:192
    ds_read_u16 v35, v19 offset:200
    ds_read_u16 v8, v18 offset:320
    ds_read_u16 v40, v18 offset:328
    ds_read_u16 v9, v18 offset:256
    ds_read_u16 v41, v18 offset:264
    ds_read_u16 v10, v19 offset:448
    ds_read_u16 v42, v19 offset:456
    ds_read_u16 v11, v19 offset:384
    ds_read_u16 v43, v19 offset:392
    s_mov_b32 s46, 0
    buffer_load_dwordx4 v[160:163], v126, s[12:15], s46 offen offset:0
    buffer_load_dwordx4 v[164:167], v126, s[12:15], s46 offen offset:1024
    buffer_load_dwordx4 v[168:171], v126, s[12:15], s46 offen offset:2048
    buffer_load_dwordx4 v[172:175], v126, s[12:15], s46 offen offset:3072
    s_waitcnt vmcnt(8)
    v_mfma_f32_16x16x32_bf16 v[192:195], v[82:85], v[176:179], 0
    v_mfma_f32_16x16x32_bf16 v[196:199], v[80:83], v[176:179], 0
    v_mfma_f32_16x16x32_bf16 v[200:203], v[82:85], v[180:183], 0
    v_mfma_f32_16x16x32_bf16 v[204:207], v[80:83], v[180:183], 0
    v_mfma_f32_16x16x32_bf16 v[208:211], v[82:85], v[184:187], 0
    v_mfma_f32_16x16x32_bf16 v[212:215], v[80:83], v[184:187], 0
    v_mfma_f32_16x16x32_bf16 v[216:219], v[82:85], v[188:191], 0
    v_mfma_f32_16x16x32_bf16 v[220:223], v[80:83], v[188:191], 0
    s_nop 0
    v_pk_mul_f32 v[192:193], v[192:193], s[100:101]
    v_pk_mul_f32 v[194:195], v[194:195], s[100:101]
    v_pk_mul_f32 v[196:197], v[196:197], s[100:101]
    v_pk_mul_f32 v[198:199], v[198:199], s[100:101]
    v_pk_mul_f32 v[200:201], v[200:201], s[100:101]
    v_pk_mul_f32 v[202:203], v[202:203], s[100:101]
    v_pk_mul_f32 v[204:205], v[204:205], s[100:101]
    v_pk_mul_f32 v[206:207], v[206:207], s[100:101]
    v_pk_mul_f32 v[208:209], v[208:209], s[100:101]
    v_pk_mul_f32 v[210:211], v[210:211], s[100:101]
    v_pk_mul_f32 v[212:213], v[212:213], s[100:101]
    v_pk_mul_f32 v[214:215], v[214:215], s[100:101]
    v_pk_mul_f32 v[216:217], v[216:217], s[100:101]
    v_pk_mul_f32 v[218:219], v[218:219], s[100:101]
    v_pk_mul_f32 v[220:221], v[220:221], s[100:101]
    v_pk_mul_f32 v[222:223], v[222:223], s[100:101]
    v_cvt_pk_bf16_f32 v192, v192, v193
    v_cvt_pk_bf16_f32 v193, v194, v195
    v_cvt_pk_bf16_f32 v196, v196, v197
    v_cvt_pk_bf16_f32 v197, v198, v199
    v_cvt_pk_bf16_f32 v200, v200, v201
    v_cvt_pk_bf16_f32 v201, v202, v203
    v_cvt_pk_bf16_f32 v204, v204, v205
    v_cvt_pk_bf16_f32 v205, v206, v207
    v_cvt_pk_bf16_f32 v208, v208, v209
    v_cvt_pk_bf16_f32 v209, v210, v211
    v_cvt_pk_bf16_f32 v212, v212, v213
    v_cvt_pk_bf16_f32 v213, v214, v215
    v_cvt_pk_bf16_f32 v216, v216, v217
    v_cvt_pk_bf16_f32 v217, v218, v219
    v_cvt_pk_bf16_f32 v220, v220, v221
    v_cvt_pk_bf16_f32 v221, v222, v223
    ds_write_b64 v108, v[192:193] offset:0
    ds_write_b64 v108, v[196:197] offset:64
    ds_write_b64 v108, v[200:201] offset:1024
    ds_write_b64 v108, v[204:205] offset:1088
    ds_write_b64 v108, v[208:209] offset:8
    ds_write_b64 v108, v[212:213] offset:72
    ds_write_b64 v108, v[216:217] offset:1032
    ds_write_b64 v108, v[220:221] offset:1096
    s_mov_b32 s46, 32768
    buffer_load_dwordx4 v[128:131], v126, s[12:15], s46 offen offset:0
    buffer_load_dwordx4 v[132:135], v126, s[12:15], s46 offen offset:1024
    buffer_load_dwordx4 v[136:139], v126, s[12:15], s46 offen offset:2048
    buffer_load_dwordx4 v[140:143], v126, s[12:15], s46 offen offset:3072
    s_waitcnt vmcnt(17)
    v_lshlrev_b32 v112, 16, v104
    v_and_b32 v113, 0xffff0000, v104
    v_lshlrev_b32 v114, 16, v105
    v_and_b32 v115, 0xffff0000, v105
    s_mov_b32 s43, 0x3c003c00
    v_pk_mul_f32 v[112:113], v[112:113], s[100:101]
    v_pk_mul_f32 v[114:115], v[114:115], s[100:101]
    s_cmp_lg_u32 s36, 0
    s_cbranch_scc1 L_NOW2B
    v_lshlrev_b32 v76, 16, v106
    v_and_b32 v77, 0xffff0000, v106
    v_and_b32 v78, 0x7fffffff, v76
    v_and_b32 v79, 0x7fffffff, v77
    v_max_u32 v78, v78, v79
    v_lshlrev_b32 v107, 16, v107
    s_nop 0
    v_max_u32_dpp v78, v78, v78 row_shr:1 row_mask:0xf bank_mask:0xf
    s_nop 1
    v_max_u32_dpp v78, v78, v78 row_shr:2 row_mask:0xf bank_mask:0xf
    s_nop 1
    v_max_u32_dpp v78, v78, v78 row_shr:4 row_mask:0xf bank_mask:0xf
    s_nop 1
    v_max_u32_dpp v78, v78, v78 row_shr:8 row_mask:0xf bank_mask:0xf
    s_nop 1
    v_readlane_b32 s46, v78, 15
    v_readlane_b32 s47, v78, 31
    v_readlane_b32 s72, v78, 47
    v_readlane_b32 s73, v78, 63
    s_max_u32 s46, s46, s47
    s_max_u32 s72, s72, s73
    s_max_u32 s46, s46, s72
    s_lshr_b32 s46, s46, 23
    s_max_u32 s46, s46, 81
    s_sub_u32 s47, 268, s46
    s_lshl_b32 s44, s47, 23
    s_sub_u32 s47, s46, 14
    s_lshl_b32 s45, s47, 23
    v_mul_f32 v76, s44, v76
    v_mul_f32 v77, s44, v77
    v_cvt_pk_f16_f32 v76, v76, v77
    v_add_u32 v79, 155520, v111
    ds_write_b32 v79, v76
    v_mul_f32 v76, s44, v107
    v_mov_b32 v77, s45
    v_cmp_eq_u32 vcc, 4, v0
    v_add_u32 v79, 159936, v111
    s_nop 0
    v_cndmask_b32 v76, v76, v77, vcc
    s_mov_b64 exec, 0x1f
    ds_write_b32 v79, v76
    s_mov_b64 exec, -1
L_NOW2B:
    s_waitcnt lgkmcnt(0)
    v_lshl_add_u32 v24, v24, 8, v15
    v_lshl_add_u32 v25, v25, 8, v15
    v_lshl_add_u32 v26, v26, 8, v15
    v_lshl_add_u32 v27, v27, 8, v15
    s_waitcnt vmcnt(4)
    v_mfma_f32_16x16x32_bf16 v[224:227], v[82:85], v[144:147], 0
    v_mfma_f32_16x16x32_bf16 v[228:231], v[80:83], v[144:147], 0
    v_mfma_f32_16x16x32_bf16 v[232:235], v[82:85], v[148:151], 0
    v_mfma_f32_16x16x32_bf16 v[236:239], v[80:83], v[148:151], 0
    v_mfma_f32_16x16x32_bf16 v[240:243], v[82:85], v[152:155], 0
    v_mfma_f32_16x16x32_bf16 v[244:247], v[80:83], v[152:155], 0
    v_mfma_f32_16x16x32_bf16 v[248:251], v[82:85], v[156:159], 0
    v_mfma_f32_16x16x32_bf16 v[252:255], v[80:83], v[156:159], 0
    v_mfma_f32_16x16x32_bf16 v[224:227], v[82:85], v[160:163], v[224:227]
    v_mfma_f32_16x16x32_bf16 v[228:231], v[80:83], v[160:163], v[228:231]
    v_mfma_f32_16x16x32_bf16 v[232:235], v[82:85], v[164:167], v[232:235]
    v_mfma_f32_16x16x32_bf16 v[236:239], v[80:83], v[164:167], v[236:239]
    v_mfma_f32_16x16x32_bf16 v[240:243], v[82:85], v[168:171], v[240:243]
    v_mfma_f32_16x16x32_bf16 v[244:247], v[80:83], v[168:171], v[244:247]
    v_mfma_f32_16x16x32_bf16 v[248:251], v[82:85], v[172:175], v[248:251]
    v_mfma_f32_16x16x32_bf16 v[252:255], v[80:83], v[172:175], v[252:255]
    s_nop 0
    v_pk_mul_f32 v[224:225], v[224:225], s[100:101]
    v_pk_mul_f32 v[226:227], v[226:227], s[100:101]
    v_pk_mul_f32 v[228:229], v[228:229], s[100:101]
    v_pk_mul_f32 v[230:231], v[230:231], s[100:101]
    v_pk_mul_f32 v[232:233], v[232:233], s[100:101]
    v_pk_mul_f32 v[234:235], v[234:235], s[100:101]
    v_pk_mul_f32 v[236:237], v[236:237], s[100:101]
    v_pk_mul_f32 v[238:239], v[238:239], s[100:101]
    v_pk_mul_f32 v[240:241], v[240:241], s[100:101]
    v_pk_mul_f32 v[242:243], v[242:243], s[100:101]
    v_pk_mul_f32 v[244:245], v[244:245], s[100:101]
    v_pk_mul_f32 v[246:247], v[246:247], s[100:101]
    v_pk_mul_f32 v[248:249], v[248:249], s[100:101]
    v_pk_mul_f32 v[250:251], v[250:251], s[100:101]
    v_pk_mul_f32 v[252:253], v[252:253], s[100:101]
    v_pk_mul_f32 v[254:255], v[254:255], s[100:101]
    v_cvt_pk_bf16_f32 v224, v224, v225
    v_cvt_pk_bf16_f32 v225, v226, v227
    v_cvt_pk_bf16_f32 v228, v228, v229
    v_cvt_pk_bf16_f32 v229, v230, v231
    v_cvt_pk_bf16_f32 v232, v232, v233
    v_cvt_pk_bf16_f32 v233, v234, v235
    v_cvt_pk_bf16_f32 v236, v236, v237
    v_cvt_pk_bf16_f32 v237, v238, v239
    v_cvt_pk_bf16_f32 v240, v240, v241
    v_cvt_pk_bf16_f32 v241, v242, v243
    v_cvt_pk_bf16_f32 v244, v244, v245
    v_cvt_pk_bf16_f32 v245, v246, v247
    v_cvt_pk_bf16_f32 v248, v248, v249
    v_cvt_pk_bf16_f32 v249, v250, v251
    v_cvt_pk_bf16_f32 v252, v252, v253
    v_cvt_pk_bf16_f32 v253, v254, v255
    ds_write_b64 v108, v[224:225] offset:512
    ds_write_b64 v108, v[228:229] offset:576
    ds_write_b64 v108, v[232:233] offset:1536
    ds_write_b64 v108, v[236:237] offset:1600
    ds_write_b64 v108, v[240:241] offset:520
    ds_write_b64 v108, v[244:245] offset:584
    ds_write_b64 v108, v[248:249] offset:1544
    ds_write_b64 v108, v[252:253] offset:1608
    s_add_u32 m0, s37, 0
    s_nop 0
    buffer_load_dwordx4 v24, s[4:7], 0 offen nt lds
    s_add_u32 m0, s37, 1024
    s_nop 0
    buffer_load_dwordx4 v25, s[4:7], 0 offen nt lds
    s_add_u32 m0, s37, 2080
    s_nop 0
    buffer_load_dwordx4 v26, s[4:7], 0 offen nt lds
    s_add_u32 m0, s37, 3104
    s_nop 0
    buffer_load_dwordx4 v27, s[4:7], 0 offen nt lds
    v_lshl_or_b32 v36, v32, 16, v36
    v_lshl_or_b32 v8, v40, 16, v8
    v_lshl_or_b32 v37, v33, 16, v37
    v_lshl_or_b32 v9, v41, 16, v9
    v_lshl_or_b32 v38, v34, 16, v38
    v_lshl_or_b32 v10, v42, 16, v10
    v_lshl_or_b32 v39, v35, 16, v39
    v_lshl_or_b32 v11, v43, 16, v11
    v_lshl_add_u32 v32, v44, 8, v15
    v_lshl_add_u32 v33, v45, 8, v15
    v_lshl_add_u32 v34, v46, 8, v15
    v_lshl_add_u32 v35, v47, 8, v15
    s_waitcnt vmcnt(4)
    v_mfma_f32_16x16x32_bf16 v[192:195], v[82:85], v[128:131], 0
    v_mfma_f32_16x16x32_bf16 v[196:199], v[80:83], v[128:131], 0
    v_mfma_f32_16x16x32_bf16 v[200:203], v[82:85], v[132:135], 0
    v_mfma_f32_16x16x32_bf16 v[204:207], v[80:83], v[132:135], 0
    v_mfma_f32_16x16x32_bf16 v[208:211], v[82:85], v[136:139], 0
    v_mfma_f32_16x16x32_bf16 v[212:215], v[80:83], v[136:139], 0
    v_mfma_f32_16x16x32_bf16 v[216:219], v[82:85], v[140:143], 0
    v_mfma_f32_16x16x32_bf16 v[220:223], v[80:83], v[140:143], 0
    v_mfma_f32_16x16x32_bf16 v[192:195], v[88:91], v[144:147], v[192:195]
    v_mfma_f32_16x16x32_bf16 v[196:199], v[86:89], v[144:147], v[196:199]
    v_mfma_f32_16x16x32_bf16 v[200:203], v[88:91], v[148:151], v[200:203]
    v_mfma_f32_16x16x32_bf16 v[204:207], v[86:89], v[148:151], v[204:207]
    v_mfma_f32_16x16x32_bf16 v[208:211], v[88:91], v[152:155], v[208:211]
    v_mfma_f32_16x16x32_bf16 v[212:215], v[86:89], v[152:155], v[212:215]
    v_mfma_f32_16x16x32_bf16 v[216:219], v[88:91], v[156:159], v[216:219]
    v_mfma_f32_16x16x32_bf16 v[220:223], v[86:89], v[156:159], v[220:223]
    s_nop 0
    v_pk_mul_f32 v[192:193], v[192:193], s[100:101]
    v_pk_mul_f32 v[194:195], v[194:195], s[100:101]
    v_pk_mul_f32 v[196:197], v[196:197], s[100:101]
    v_pk_mul_f32 v[198:199], v[198:199], s[100:101]
    v_pk_mul_f32 v[200:201], v[200:201], s[100:101]
    v_pk_mul_f32 v[202:203], v[202:203], s[100:101]
    v_pk_mul_f32 v[204:205], v[204:205], s[100:101]
    v_pk_mul_f32 v[206:207], v[206:207], s[100:101]
    v_pk_mul_f32 v[208:209], v[208:209], s[100:101]
    v_pk_mul_f32 v[210:211], v[210:211], s[100:101]
    v_pk_mul_f32 v[212:213], v[212:213], s[100:101]
    v_pk_mul_f32 v[214:215], v[214:215], s[100:101]
    v_pk_mul_f32 v[216:217], v[216:217], s[100:101]
    v_pk_mul_f32 v[218:219], v[218:219], s[100:101]
    v_pk_mul_f32 v[220:221], v[220:221], s[100:101]
    v_pk_mul_f32 v[222:223], v[222:223], s[100:101]
    v_cvt_pk_bf16_f32 v192, v192, v193
    v_cvt_pk_bf16_f32 v193, v194, v195
    v_cvt_pk_bf16_f32 v196, v196, v197
    v_cvt_pk_bf16_f32 v197, v198, v199
    v_cvt_pk_bf16_f32 v200, v200, v201
    v_cvt_pk_bf16_f32 v201, v202, v203
    v_cvt_pk_bf16_f32 v204, v204, v205
    v_cvt_pk_bf16_f32 v205, v206, v207
    v_cvt_pk_bf16_f32 v208, v208, v209
    v_cvt_pk_bf16_f32 v209, v210, v211
    v_cvt_pk_bf16_f32 v212, v212, v213
    v_cvt_pk_bf16_f32 v213, v214, v215
    v_cvt_pk_bf16_f32 v216, v216, v217
    v_cvt_pk_bf16_f32 v217, v218, v219
    v_cvt_pk_bf16_f32 v220, v220, v221
    v_cvt_pk_bf16_f32 v221, v222, v223
    ds_write_b64 v109, v[192:193] offset:0
    ds_write_b64 v109, v[196:197] offset:64
    ds_write_b64 v109, v[200:201] offset:8
    ds_write_b64 v109, v[204:205] offset:72
    ds_write_b64 v109, v[208:209] offset:256
    ds_write_b64 v109, v[212:213] offset:320
    ds_write_b64 v109, v[216:217] offset:264
    ds_write_b64 v109, v[220:221] offset:328
    s_lshr_b32 s46, s36, 1
    v_xor_b32 v120, s46, v0
    v_lshlrev_b32 v120, 4, v120
    s_add_u32 s46, s37, 4128
    v_add_u32 v120, s46, v120
    s_lshl_b32 s46, s36, 6
    s_add_u32 s46, s46, 131712
    v_mul_u32_u24 v121, 528, v1
    v_lshl_add_u32 v121, v2, 4, v121
    v_add_u32 v121, s46, v121
    s_waitcnt lgkmcnt(0)
    s_barrier
    ds_read_b128 v[128:131], v120 offset:0
    ds_read_b128 v[80:83], v92
    ds_read_b128 v[132:135], v120 offset:1024
    ds_read_b128 v[84:87], v93
    ds_read_b128 v[136:139], v120 offset:2048
    ds_read_b128 v[88:91], v94
    ds_read_b128 v[140:143], v120 offset:3072
    ds_read_b128 v[92:95], v95
    s_mov_b32 s41, 0
    s_mov_b32 s38, s39
    v_lshlrev_b32 v79, 3, v2
    v_add_u32 v79, 155520, v79
    v_mov_b32 v78, 159936
    s_waitcnt lgkmcnt(0)
    v_mfma_f32_16x16x32_bf16 v[112:115], v[128:131], v[80:83], v[112:115]
    v_mfma_f32_16x16x32_bf16 v[112:115], v[132:135], v[84:87], v[112:115]
    v_mfma_f32_16x16x32_bf16 v[112:115], v[136:139], v[88:91], v[112:115]
    v_mfma_f32_16x16x32_bf16 v[112:115], v[140:143], v[92:95], v[112:115]
    ds_read2_b64 v[48:51], v79 offset0:0 offset1:4
    ds_read2_b64 v[52:55], v79 offset0:8 offset1:12
    ds_read2_b64 v[56:59], v79 offset0:16 offset1:20
    ds_read2_b64 v[60:63], v79 offset0:24 offset1:28
    ds_read_b128 v[28:31], v78
    ds_read_b32 v18, v78 offset:16
    s_nop 1
    ds_write_b128 v121, v[112:115]
    s_waitcnt lgkmcnt(0)
    s_barrier
    v_readfirstlane_b32 s45, v18
    s_setprio 1
    s_mov_b32 s42, 0x7fffffff
    s_cmp_ge_u32 s36, 4
    s_cbranch_scc1 L_PRIO_B
    s_setprio 2
    s_add_u32 s42, s39, 1
L_PRIO_B:
L_BUILD:
    v_lshlrev_b32 v1, 4, v0
    s_mov_b32 vcc_lo, -1
    s_mov_b32 vcc_hi, 0
    v_mov_b32 v2, 0x3f803f80
    v_cndmask_b32 v36, v2, v36, vcc
    v_cndmask_b32 v37, v2, v37, vcc
    v_cndmask_b32 v38, v2, v38, vcc
    v_cndmask_b32 v39, v2, v39, vcc
    ds_read_b128 v[80:83], v1 offset:0
    ds_read_b128 v[84:87], v1 offset:1024
    ds_read_b128 v[88:91], v1 offset:8208
    ds_read_b128 v[92:95], v1 offset:9232
    ds_read_b128 v[96:99], v1 offset:16416
    ds_read_b128 v[100:103], v1 offset:17440
    v_perm_b32 v64, v36, v36, v4
    v_perm_b32 v65, v36, v36, v5
    v_perm_b32 v66, v36, v36, v6
    v_perm_b32 v67, v36, v36, v7
    v_lshrrev_b32 v2, 16, v36
    v_perm_b32 v68, v2, v2, v4
    v_perm_b32 v69, v2, v2, v5
    v_perm_b32 v70, v2, v2, v6
    v_perm_b32 v71, v2, v2, v7
    ds_read_b128 v[104:107], v1 offset:24624
    ds_read_b128 v[108:111], v1 offset:25648
    s_waitcnt lgkmcnt(6)
    v_mfma_f32_16x16x32_bf16 v[112:115], v[64:67], v[80:83], 0
    v_mfma_f32_16x16x32_bf16 v[116:119], v[68:71], v[84:87], 0
    ds_read_b128 v[80:83], v1 offset:32832
    ds_read_b128 v[84:87], v1 offset:33856
    s_waitcnt lgkmcnt(6)
    v_mfma_f32_16x16x32_bf16 v[120:123], v[64:67], v[88:91], 0
    v_mfma_f32_16x16x32_bf16 v[124:127], v[68:71], v[92:95], 0
    ds_read_b128 v[88:91], v1 offset:41040
    ds_read_b128 v[92:95], v1 offset:42064
    s_waitcnt lgkmcnt(6)
    v_mfma_f32_16x16x32_bf16 v[40:43], v[64:67], v[96:99], 0
    v_cvt_pk_bf16_f32 v128, v112, v113
    v_cvt_pk_bf16_f32 v129, v114, v115
    v_perm_b32 v72, v37, v37, v4
    v_mfma_f32_16x16x32_bf16 v[44:47], v[68:71], v[100:103], 0
    v_cvt_pk_bf16_f32 v130, v116, v117
    v_cvt_pk_bf16_f32 v131, v118, v119
    v_perm_b32 v73, v37, v37, v5
    ds_read_b128 v[96:99], v1 offset:49248
    ds_read_b128 v[100:103], v1 offset:50272
    s_waitcnt lgkmcnt(6)
    v_mfma_f32_16x16x32_bf16 v[112:115], v[64:67], v[104:107], 0
    v_cvt_pk_bf16_f32 v144, v120, v121
    v_cvt_pk_bf16_f32 v145, v122, v123
    v_perm_b32 v74, v37, v37, v6
    v_mfma_f32_16x16x32_bf16 v[116:119], v[68:71], v[108:111], 0
    v_cvt_pk_bf16_f32 v146, v124, v125
    v_cvt_pk_bf16_f32 v147, v126, v127
    v_perm_b32 v75, v37, v37, v7
    ds_read_b128 v[104:107], v1 offset:57456
    ds_read_b128 v[108:111], v1 offset:58480
    s_waitcnt lgkmcnt(6)
    v_mfma_f32_16x16x32_bf16 v[120:123], v[64:67], v[80:83], 0
    v_cvt_pk_bf16_f32 v160, v40, v41
    v_cvt_pk_bf16_f32 v161, v42, v43
    v_lshrrev_b32 v2, 16, v37
    v_mfma_f32_16x16x32_bf16 v[124:127], v[68:71], v[84:87], 0
    v_cvt_pk_bf16_f32 v162, v44, v45
    v_cvt_pk_bf16_f32 v163, v46, v47
    v_perm_b32 v76, v2, v2, v4
    ds_read_b128 v[80:83], v1 offset:2048
    ds_read_b128 v[84:87], v1 offset:3072
    s_waitcnt lgkmcnt(6)
    v_mfma_f32_16x16x32_bf16 v[40:43], v[64:67], v[88:91], 0
    v_cvt_pk_bf16_f32 v176, v112, v113
    v_cvt_pk_bf16_f32 v177, v114, v115
    v_perm_b32 v77, v2, v2, v5
    v_mfma_f32_16x16x32_bf16 v[44:47], v[68:71], v[92:95], 0
    v_cvt_pk_bf16_f32 v178, v116, v117
    v_cvt_pk_bf16_f32 v179, v118, v119
    v_perm_b32 v78, v2, v2, v6
    ds_read_b128 v[88:91], v1 offset:10256
    ds_read_b128 v[92:95], v1 offset:11280
    s_waitcnt lgkmcnt(6)
    v_mfma_f32_16x16x32_bf16 v[112:115], v[64:67], v[96:99], 0
    v_cvt_pk_bf16_f32 v192, v120, v121
    v_cvt_pk_bf16_f32 v193, v122, v123
    v_perm_b32 v79, v2, v2, v7
    v_mfma_f32_16x16x32_bf16 v[116:119], v[68:71], v[100:103], 0
    v_cvt_pk_bf16_f32 v194, v124, v125
    v_cvt_pk_bf16_f32 v195, v126, v127
    ds_read_b128 v[96:99], v1 offset:18464
    ds_read_b128 v[100:103], v1 offset:19488
    s_waitcnt lgkmcnt(6)
    v_mfma_f32_16x16x32_bf16 v[120:123], v[64:67], v[104:107], 0
    v_cvt_pk_bf16_f32 v208, v40, v41
    v_cvt_pk_bf16_f32 v209, v42, v43
    v_mfma_f32_16x16x32_bf16 v[124:127], v[68:71], v[108:111], 0
    v_cvt_pk_bf16_f32 v210, v44, v45
    v_cvt_pk_bf16_f32 v211, v46, v47
    ds_read_b128 v[104:107], v1 offset:26672
    ds_read_b128 v[108:111], v1 offset:27696
    s_waitcnt lgkmcnt(6)
    v_mfma_f32_16x16x32_bf16 v[40:43], v[72:75], v[80:83], 0
    v_cvt_pk_bf16_f32 v224, v112, v113
    v_cvt_pk_bf16_f32 v225, v114, v115
    v_mfma_f32_16x16x32_bf16 v[44:47], v[76:79], v[84:87], 0
    v_cvt_pk_bf16_f32 v226, v116, v117
    v_cvt_pk_bf16_f32 v227, v118, v119
    ds_read_b128 v[80:83], v1 offset:34880
    ds_read_b128 v[84:87], v1 offset:35904
    s_waitcnt lgkmcnt(6)
    v_mfma_f32_16x16x32_bf16 v[112:115], v[72:75], v[88:91], 0
    v_cvt_pk_bf16_f32 v240, v120, v121
    v_cvt_pk_bf16_f32 v241, v122, v123
    v_mfma_f32_16x16x32_bf16 v[116:119], v[76:79], v[92:95], 0
    v_cvt_pk_bf16_f32 v242, v124, v125
    v_cvt_pk_bf16_f32 v243, v126, v127
    ds_read_b128 v[88:91], v1 offset:43088
    ds_read_b128 v[92:95], v1 offset:44112
    s_waitcnt lgkmcnt(6)
    v_mfma_f32_16x16x32_bf16 v[120:123], v[72:75], v[96:99], 0
    v_cvt_pk_bf16_f32 v132, v40, v41
    v_cvt_pk_bf16_f32 v133, v42, v43
    v_perm_b32 v64, v38, v38, v4
    v_mfma_f32_16x16x32_bf16 v[124:127], v[76:79], v[100:103], 0
    v_cvt_pk_bf16_f32 v134, v44, v45
    v_cvt_pk_bf16_f32 v135, v46, v47
    v_perm_b32 v65, v38, v38, v5
    ds_read_b128 v[96:99], v1 offset:51296
    ds_read_b128 v[100:103], v1 offset:52320
    s_waitcnt lgkmcnt(6)
    v_mfma_f32_16x16x32_bf16 v[40:43], v[72:75], v[104:107], 0
    v_cvt_pk_bf16_f32 v148, v112, v113
    v_cvt_pk_bf16_f32 v149, v114, v115
    v_perm_b32 v66, v38, v38, v6
    v_mfma_f32_16x16x32_bf16 v[44:47], v[76:79], v[108:111], 0
    v_cvt_pk_bf16_f32 v150, v116, v117
    v_cvt_pk_bf16_f32 v151, v118, v119
    v_perm_b32 v67, v38, v38, v7
    ds_read_b128 v[104:107], v1 offset:59504
    ds_read_b128 v[108:111], v1 offset:60528
    s_waitcnt lgkmcnt(6)
    v_mfma_f32_16x16x32_bf16 v[112:115], v[72:75], v[80:83], 0
    v_cvt_pk_bf16_f32 v164, v120, v121
    v_cvt_pk_bf16_f32 v165, v122, v123
    v_lshrrev_b32 v2, 16, v38
    v_mfma_f32_16x16x32_bf16 v[116:119], v[76:79], v[84:87], 0
    v_cvt_pk_bf16_f32 v166, v124, v125
    v_cvt_pk_bf16_f32 v167, v126, v127
    v_perm_b32 v68, v2, v2, v4
    ds_read_b128 v[80:83], v1 offset:4096
    ds_read_b128 v[84:87], v1 offset:5120
    s_waitcnt lgkmcnt(6)
    v_mfma_f32_16x16x32_bf16 v[120:123], v[72:75], v[88:91], 0
    v_cvt_pk_bf16_f32 v180, v40, v41
    v_cvt_pk_bf16_f32 v181, v42, v43
    v_perm_b32 v69, v2, v2, v5
    v_mfma_f32_16x16x32_bf16 v[124:127], v[76:79], v[92:95], 0
    v_cvt_pk_bf16_f32 v182, v44, v45
    v_cvt_pk_bf16_f32 v183, v46, v47
    v_perm_b32 v70, v2, v2, v6
    ds_read_b128 v[88:91], v1 offset:12304
    ds_read_b128 v[92:95], v1 offset:13328
    s_waitcnt lgkmcnt(6)
    v_mfma_f32_16x16x32_bf16 v[40:43], v[72:75], v[96:99], 0
    v_cvt_pk_bf16_f32 v196, v112, v113
    v_cvt_pk_bf16_f32 v197, v114, v115
    v_perm_b32 v71, v2, v2, v7
    v_mfma_f32_16x16x32_bf16 v[44:47], v[76:79], v[100:103], 0
    v_cvt_pk_bf16_f32 v198, v116, v117
    v_cvt_pk_bf16_f32 v199, v118, v119
    ds_read_b128 v[96:99], v1 offset:20512
    ds_read_b128 v[100:103], v1 offset:21536
    s_waitcnt lgkmcnt(6)
    v_mfma_f32_16x16x32_bf16 v[112:115], v[72:75], v[104:107], 0
    v_cvt_pk_bf16_f32 v212, v120, v121
    v_cvt_pk_bf16_f32 v213, v122, v123
    v_mfma_f32_16x16x32_bf16 v[116:119], v[76:79], v[108:111], 0
    v_cvt_pk_bf16_f32 v214, v124, v125
    v_cvt_pk_bf16_f32 v215, v126, v127
    ds_read_b128 v[104:107], v1 offset:28720
    ds_read_b128 v[108:111], v1 offset:29744
    s_waitcnt lgkmcnt(6)
    v_mfma_f32_16x16x32_bf16 v[120:123], v[64:67], v[80:83], 0
    v_cvt_pk_bf16_f32 v228, v40, v41
    v_cvt_pk_bf16_f32 v229, v42, v43
    v_mfma_f32_16x16x32_bf16 v[124:127], v[68:71], v[84:87], 0
    v_cvt_pk_bf16_f32 v230, v44, v45
    v_cvt_pk_bf16_f32 v231, v46, v47
    s_cmp_lg_u32 s41, 0
    s_cbranch_scc1 L_NOT1
    s_add_u32 m0, s37, 4128
    s_nop 0
    buffer_load_dwordx4 v32, s[4:7], 0 offen nt lds
    s_add_u32 m0, s37, 5152
    s_nop 0
    buffer_load_dwordx4 v33, s[4:7], 0 offen nt lds
    s_add_u32 m0, s37, 6208
    s_nop 0
    buffer_load_dwordx4 v34, s[4:7], 0 offen nt lds
    s_add_u32 m0, s37, 7232
    s_nop 0
    buffer_load_dwordx4 v35, s[4:7], 0 offen nt lds
L_NOT1:
    ds_read_b128 v[80:83], v1 offset:36928
    ds_read_b128 v[84:87], v1 offset:37952
    s_waitcnt lgkmcnt(6)
    v_mfma_f32_16x16x32_bf16 v[40:43], v[64:67], v[88:91], 0
    v_cvt_pk_bf16_f32 v244, v112, v113
    v_cvt_pk_bf16_f32 v245, v114, v115
    v_mfma_f32_16x16x32_bf16 v[44:47], v[68:71], v[92:95], 0
    v_cvt_pk_bf16_f32 v246, v116, v117
    v_cvt_pk_bf16_f32 v247, v118, v119
    ds_read_b128 v[88:91], v1 offset:45136
    ds_read_b128 v[92:95], v1 offset:46160
    s_waitcnt lgkmcnt(6)
    v_mfma_f32_16x16x32_bf16 v[112:115], v[64:67], v[96:99], 0
    v_cvt_pk_bf16_f32 v136, v120, v121
    v_cvt_pk_bf16_f32 v137, v122, v123
    v_perm_b32 v72, v39, v39, v4
    v_mfma_f32_16x16x32_bf16 v[116:119], v[68:71], v[100:103], 0
    v_cvt_pk_bf16_f32 v138, v124, v125
    v_cvt_pk_bf16_f32 v139, v126, v127
    v_perm_b32 v73, v39, v39, v5
    ds_read_b128 v[96:99], v1 offset:53344
    ds_read_b128 v[100:103], v1 offset:54368
    s_waitcnt lgkmcnt(6)
    v_mfma_f32_16x16x32_bf16 v[120:123], v[64:67], v[104:107], 0
    v_cvt_pk_bf16_f32 v152, v40, v41
    v_cvt_pk_bf16_f32 v153, v42, v43
    v_perm_b32 v74, v39, v39, v6
    v_mfma_f32_16x16x32_bf16 v[124:127], v[68:71], v[108:111], 0
    v_cvt_pk_bf16_f32 v154, v44, v45
    v_cvt_pk_bf16_f32 v155, v46, v47
    v_perm_b32 v75, v39, v39, v7
    ds_read_b128 v[104:107], v1 offset:61552
    ds_read_b128 v[108:111], v1 offset:62576
    s_waitcnt lgkmcnt(6)
    v_mfma_f32_16x16x32_bf16 v[40:43], v[64:67], v[80:83], 0
    v_cvt_pk_bf16_f32 v168, v112, v113
    v_cvt_pk_bf16_f32 v169, v114, v115
    v_lshrrev_b32 v2, 16, v39
    v_mfma_f32_16x16x32_bf16 v[44:47], v[68:71], v[84:87], 0
    v_cvt_pk_bf16_f32 v170, v116, v117
    v_cvt_pk_bf16_f32 v171, v118, v119
    v_perm_b32 v76, v2, v2, v4
    ds_read_b128 v[80:83], v1 offset:6144
    ds_read_b128 v[84:87], v1 offset:7168
    s_waitcnt lgkmcnt(6)
    v_mfma_f32_16x16x32_bf16 v[112:115], v[64:67], v[88:91], 0
    v_cvt_pk_bf16_f32 v184, v120, v121
    v_cvt_pk_bf16_f32 v185, v122, v123
    v_perm_b32 v77, v2, v2, v5
    v_mfma_f32_16x16x32_bf16 v[116:119], v[68:71], v[92:95], 0
    v_cvt_pk_bf16_f32 v186, v124, v125
    v_cvt_pk_bf16_f32 v187, v126, v127
    v_perm_b32 v78, v2, v2, v6
    ds_read_b128 v[88:91], v1 offset:14352
    ds_read_b128 v[92:95], v1 offset:15376
    s_waitcnt lgkmcnt(6)
    v_mfma_f32_16x16x32_bf16 v[120:123], v[64:67], v[96:99], 0
    v_cvt_pk_bf16_f32 v200, v40, v41
    v_cvt_pk_bf16_f32 v201, v42, v43
    v_perm_b32 v79, v2, v2, v7
    v_mfma_f32_16x16x32_bf16 v[124:127], v[68:71], v[100:103], 0
    v_cvt_pk_bf16_f32 v202, v44, v45
    v_cvt_pk_bf16_f32 v203, v46, v47
    ds_read_b128 v[96:99], v1 offset:22560
    ds_read_b128 v[100:103], v1 offset:23584
    s_waitcnt lgkmcnt(6)
    v_mfma_f32_16x16x32_bf16 v[40:43], v[64:67], v[104:107], 0
    v_cvt_pk_bf16_f32 v216, v112, v113
    v_cvt_pk_bf16_f32 v217, v114, v115
    v_mfma_f32_16x16x32_bf16 v[44:47], v[68:71], v[108:111], 0
    v_cvt_pk_bf16_f32 v218, v116, v117
    v_cvt_pk_bf16_f32 v219, v118, v119
    ds_read_b128 v[104:107], v1 offset:30768
    ds_read_b128 v[108:111], v1 offset:31792
    s_waitcnt lgkmcnt(6)
    v_mfma_f32_16x16x32_bf16 v[112:115], v[72:75], v[80:83], 0
    v_cvt_pk_bf16_f32 v232, v120, v121
    v_cvt_pk_bf16_f32 v233, v122, v123
    v_mfma_f32_16x16x32_bf16 v[116:119], v[76:79], v[84:87], 0
    v_cvt_pk_bf16_f32 v234, v124, v125
    v_cvt_pk_bf16_f32 v235, v126, v127
    ds_read_b128 v[80:83], v1 offset:38976
    ds_read_b128 v[84:87], v1 offset:40000
    s_waitcnt lgkmcnt(6)
    v_mfma_f32_16x16x32_bf16 v[120:123], v[72:75], v[88:91], 0
    v_cvt_pk_bf16_f32 v248, v40, v41
    v_cvt_pk_bf16_f32 v249, v42, v43
    v_mfma_f32_16x16x32_bf16 v[124:127], v[76:79], v[92:95], 0
    v_cvt_pk_bf16_f32 v250, v44, v45
    v_cvt_pk_bf16_f32 v251, v46, v47
    ds_read_b128 v[88:91], v1 offset:47184
    ds_read_b128 v[92:95], v1 offset:48208
    s_waitcnt lgkmcnt(6)
    v_mfma_f32_16x16x32_bf16 v[40:43], v[72:75], v[96:99], 0
    v_cvt_pk_bf16_f32 v140, v112, v113
    v_cvt_pk_bf16_f32 v141, v114, v115
    v_mfma_f32_16x16x32_bf16 v[44:47], v[76:79], v[100:103], 0
    v_cvt_pk_bf16_f32 v142, v116, v117
    v_cvt_pk_bf16_f32 v143, v118, v119
    ds_read_b128 v[96:99], v1 offset:55392
    ds_read_b128 v[100:103], v1 offset:56416
    s_waitcnt lgkmcnt(6)
    v_mfma_f32_16x16x32_bf16 v[112:115], v[72:75], v[104:107], 0
    v_cvt_pk_bf16_f32 v156, v120, v121
    v_cvt_pk_bf16_f32 v157, v122, v123
    v_mfma_f32_16x16x32_bf16 v[116:119], v[76:79], v[108:111], 0
    v_cvt_pk_bf16_f32 v158, v124, v125
    v_cvt_pk_bf16_f32 v159, v126, v127
    ds_read_b128 v[104:107], v1 offset:63600
    ds_read_b128 v[108:111], v1 offset:64624
    s_waitcnt lgkmcnt(6)
    v_mfma_f32_16x16x32_bf16 v[120:123], v[72:75], v[80:83], 0
    v_cvt_pk_bf16_f32 v172, v40, v41
    v_cvt_pk_bf16_f32 v173, v42, v43
    v_mfma_f32_16x16x32_bf16 v[124:127], v[76:79], v[84:87], 0
    v_cvt_pk_bf16_f32 v174, v44, v45
    v_cvt_pk_bf16_f32 v175, v46, v47
    s_waitcnt lgkmcnt(4)
    v_mfma_f32_16x16x32_bf16 v[40:43], v[72:75], v[88:91], 0
    v_cvt_pk_bf16_f32 v188, v112, v113
    v_cvt_pk_bf16_f32 v189, v114, v115
    v_mfma_f32_16x16x32_bf16 v[44:47], v[76:79], v[92:95], 0
    v_cvt_pk_bf16_f32 v190, v116, v117
    v_cvt_pk_bf16_f32 v191, v118, v119
    s_waitcnt lgkmcnt(2)
    v_mfma_f32_16x16x32_bf16 v[112:115], v[72:75], v[96:99], 0
    v_cvt_pk_bf16_f32 v204, v120, v121
    v_cvt_pk_bf16_f32 v205, v122, v123
    v_mfma_f32_16x16x32_bf16 v[116:119], v[76:79], v[100:103], 0
    v_cvt_pk_bf16_f32 v206, v124, v125
    v_cvt_pk_bf16_f32 v207, v126, v127
    s_waitcnt lgkmcnt(0)
    v_mfma_f32_16x16x32_bf16 v[120:123], v[72:75], v[104:107], 0
    v_cvt_pk_bf16_f32 v220, v40, v41
    v_cvt_pk_bf16_f32 v221, v42, v43
    v_mfma_f32_16x16x32_bf16 v[124:127], v[76:79], v[108:111], 0
    v_cvt_pk_bf16_f32 v222, v44, v45
    v_cvt_pk_bf16_f32 v223, v46, v47
    v_cvt_pk_bf16_f32 v236, v112, v113
    v_cvt_pk_bf16_f32 v237, v114, v115
    v_cvt_pk_bf16_f32 v238, v116, v117
    v_cvt_pk_bf16_f32 v239, v118, v119
    v_cvt_pk_bf16_f32 v252, v120, v121
    v_cvt_pk_bf16_f32 v253, v122, v123
    v_cvt_pk_bf16_f32 v254, v124, v125
    v_cvt_pk_bf16_f32 v255, v126, v127
    v_mov_b32 v40, 0
    v_mov_b32 v41, 0
    v_mov_b32 v42, 0
    v_mov_b32 v43, 0
    v_mov_b32 v44, 0
    v_mov_b32 v45, 0
    v_mov_b32 v46, 0
    v_mov_b32 v47, 0
    s_and_b32 s46, s39, s41
    s_cmp_eq_u32 s46, 1
    s_cbranch_scc1 L_FIRST1
L_FIRST0:
    s_waitcnt vmcnt(4)
    ds_read_b128 v[96:99], v14 offset:0
    ds_read_b128 v[80:83], v20 offset:0
    ds_read_b128 v[100:103], v14 offset:64
    ds_read_b128 v[84:87], v21 offset:0
    ds_read_b128 v[88:91], v22 offset:0
    ds_read_b128 v[92:95], v23 offset:0
    ds_read_b128 v[104:107], v14 offset:128
    ds_read_b128 v[108:111], v14 offset:192
    ds_read_b128 v[112:115], v14 offset:256
    ds_read_b128 v[116:119], v14 offset:320
    s_waitcnt lgkmcnt(4)
    v_mfma_f32_16x16x32_bf16 v[96:99], v[128:131], v[80:83], v[96:99]
    v_mfma_f32_16x16x32_bf16 v[100:103], v[144:147], v[80:83], v[100:103]
    v_mfma_f32_16x16x32_bf16 v[96:99], v[132:135], v[84:87], v[96:99]
    v_mfma_f32_16x16x32_bf16 v[100:103], v[148:151], v[84:87], v[100:103]
    v_mfma_f32_16x16x32_bf16 v[96:99], v[136:139], v[88:91], v[96:99]
    v_mfma_f32_16x16x32_bf16 v[100:103], v[152:155], v[88:91], v[100:103]
    v_mfma_f32_16x16x32_bf16 v[96:99], v[140:143], v[92:95], v[96:99]
    v_mfma_f32_16x16x32_bf16 v[100:103], v[156:159], v[92:95], v[100:103]
    ds_read_u16 v24, v12 offset:64
    ds_read_u16 v25, v12 offset:72
    ds_read_u16 v26, v12 offset:80
    ds_read_u16 v27, v12 offset:88
    ds_read_b128 v[120:123], v14 offset:384
    ds_read_b128 v[124:127], v14 offset:448
    s_waitcnt lgkmcnt(8)
    v_mfma_f32_16x16x32_bf16 v[104:107], v[160:163], v[80:83], v[104:107]
    v_exp_f32 v96, v96
    v_exp_f32 v97, v97
    v_exp_f32 v98, v98
    v_exp_f32 v99, v99
    v_exp_f32 v100, v100
    v_exp_f32 v101, v101
    v_exp_f32 v102, v102
    ds_read_b64_tr_b16 v[64:65], v16 offset:0
    ds_read_b64_tr_b16 v[66:67], v17 offset:0
    ds_read_b64_tr_b16 v[68:69], v16 offset:1024
    ds_read_b64_tr_b16 v[70:71], v17 offset:1024
    ds_read_b64_tr_b16 v[72:73], v16 offset:2080
    ds_read_b64_tr_b16 v[74:75], v17 offset:2080
    ds_read_b64_tr_b16 v[76:77], v16 offset:3104
    ds_read_b64_tr_b16 v[78:79], v17 offset:3104
    ds_read_u16_d16_hi v32, v13 offset:0
    ds_read_u16_d16_hi v33, v13 offset:2
    ds_read_u16_d16_hi v34, v13 offset:4
    ds_read_u16_d16_hi v35, v13 offset:6
    v_mfma_f32_16x16x32_bf16 v[108:111], v[176:179], v[80:83], v[108:111]
    v_exp_f32 v103, v103
    v_cvt_pk_f16_f32 v96, v96, v97
    v_mfma_f32_16x16x32_bf16 v[104:107], v[164:167], v[84:87], v[104:107]
    v_cvt_pk_f16_f32 v97, v98, v99
    v_cvt_pk_f16_f32 v98, v100, v101
    v_mfma_f32_16x16x32_bf16 v[108:111], v[180:183], v[84:87], v[108:111]
    v_cvt_pk_f16_f32 v99, v102, v103
    v_pk_add_f16 v96, v96, s43
    v_mfma_f32_16x16x32_bf16 v[104:107], v[168:171], v[88:91], v[104:107]
    v_pk_add_f16 v97, v97, s43
    v_pk_add_f16 v98, v98, s43
    v_mfma_f32_16x16x32_bf16 v[108:111], v[184:187], v[88:91], v[108:111]
    v_pk_add_f16 v99, v99, s43
    v_rcp_f16_sdwa v96, v96 dst_sel:WORD_0 dst_unused:UNUSED_PRESERVE src0_sel:WORD_0
    v_mfma_f32_16x16x32_bf16 v[104:107], v[172:175], v[92:95], v[104:107]
    v_rcp_f16_sdwa v97, v97 dst_sel:WORD_0 dst_unused:UNUSED_PRESERVE src0_sel:WORD_0
    v_rcp_f16_sdwa v98, v98 dst_sel:WORD_0 dst_unused:UNUSED_PRESERVE src0_sel:WORD_0
    v_mfma_f32_16x16x32_bf16 v[108:111], v[188:191], v[92:95], v[108:111]
    s_waitcnt lgkmcnt(4)
    s_add_u32 m0, s37, 0
    v_lshl_add_u32 v24, v24, 8, v15
    buffer_load_dwordx4 v24, s[4:7], 0 offen nt lds
    s_add_u32 m0, s37, 1024
    v_lshl_add_u32 v25, v25, 8, v15
    buffer_load_dwordx4 v25, s[4:7], 0 offen nt lds
    v_rcp_f16_sdwa v99, v99 dst_sel:WORD_0 dst_unused:UNUSED_PRESERVE src0_sel:WORD_0
    v_mfma_f32_16x16x32_bf16 v[112:115], v[192:195], v[80:83], v[112:115]
    v_rcp_f16_sdwa v96, v96 dst_sel:WORD_1 dst_unused:UNUSED_PRESERVE src0_sel:WORD_1
    v_rcp_f16_sdwa v97, v97 dst_sel:WORD_1 dst_unused:UNUSED_PRESERVE src0_sel:WORD_1
    v_exp_f32 v104, v104
    v_mfma_f32_16x16x32_bf16 v[116:119], v[208:211], v[80:83], v[116:119]
    v_rcp_f16_sdwa v98, v98 dst_sel:WORD_1 dst_unused:UNUSED_PRESERVE src0_sel:WORD_1
    v_rcp_f16_sdwa v99, v99 dst_sel:WORD_1 dst_unused:UNUSED_PRESERVE src0_sel:WORD_1
    v_exp_f32 v105, v105
    v_mfma_f32_16x16x32_bf16 v[112:115], v[196:199], v[84:87], v[112:115]
    v_exp_f32 v106, v106
    v_exp_f32 v107, v107
    v_mfma_f32_16x16x32_f16 v[36:39], v[96:99], v[48:51], v[28:31]
    v_exp_f32 v108, v108
    v_exp_f32 v109, v109
    v_mfma_f32_16x16x32_bf16 v[116:119], v[212:215], v[84:87], v[116:119]
    v_exp_f32 v110, v110
    v_exp_f32 v111, v111
    v_mfma_f32_16x16x32_bf16 v[112:115], v[200:203], v[88:91], v[112:115]
    v_cvt_pk_f16_f32 v104, v104, v105
    v_cvt_pk_f16_f32 v105, v106, v107
    v_mfma_f32_16x16x32_bf16 v[116:119], v[216:219], v[88:91], v[116:119]
    v_cvt_pk_f16_f32 v106, v108, v109
    v_cvt_pk_f16_f32 v107, v110, v111
    v_mfma_f32_16x16x32_bf16 v[112:115], v[204:207], v[92:95], v[112:115]
    v_pk_add_f16 v104, v104, s43
    v_pk_add_f16 v105, v105, s43
    v_pk_add_f16 v106, v106, s43
    v_pk_add_f16 v107, v107, s43
    v_mfma_f32_16x16x32_bf16 v[116:119], v[220:223], v[92:95], v[116:119]
    s_add_u32 m0, s37, 2080
    v_lshl_add_u32 v26, v26, 8, v15
    buffer_load_dwordx4 v26, s[4:7], 0 offen nt lds
    s_add_u32 m0, s37, 3104
    v_lshl_add_u32 v27, v27, 8, v15
    buffer_load_dwordx4 v27, s[4:7], 0 offen nt lds
    v_rcp_f16_sdwa v104, v104 dst_sel:WORD_0 dst_unused:UNUSED_PRESERVE src0_sel:WORD_0
    v_rcp_f16_sdwa v105, v105 dst_sel:WORD_0 dst_unused:UNUSED_PRESERVE src0_sel:WORD_0
    v_rcp_f16_sdwa v106, v106 dst_sel:WORD_0 dst_unused:UNUSED_PRESERVE src0_sel:WORD_0
    v_rcp_f16_sdwa v107, v107 dst_sel:WORD_0 dst_unused:UNUSED_PRESERVE src0_sel:WORD_0
    s_waitcnt lgkmcnt(0)
    v_mfma_f32_16x16x32_bf16 v[120:123], v[224:227], v[80:83], v[120:123]
    v_rcp_f16_sdwa v104, v104 dst_sel:WORD_1 dst_unused:UNUSED_PRESERVE src0_sel:WORD_1
    v_rcp_f16_sdwa v105, v105 dst_sel:WORD_1 dst_unused:UNUSED_PRESERVE src0_sel:WORD_1
    v_exp_f32 v112, v112
    v_mfma_f32_16x16x32_bf16 v[124:127], v[240:243], v[80:83], v[124:127]
    v_rcp_f16_sdwa v106, v106 dst_sel:WORD_1 dst_unused:UNUSED_PRESERVE src0_sel:WORD_1
    v_rcp_f16_sdwa v107, v107 dst_sel:WORD_1 dst_unused:UNUSED_PRESERVE src0_sel:WORD_1
    v_exp_f32 v113, v113
    v_mfma_f32_16x16x32_bf16 v[120:123], v[228:231], v[84:87], v[120:123]
    v_exp_f32 v114, v114
    v_exp_f32 v115, v115
    v_mfma_f32_16x16x32_f16 v[36:39], v[104:107], v[52:55], v[36:39]
    v_exp_f32 v116, v116
    v_exp_f32 v117, v117
    v_mfma_f32_16x16x32_bf16 v[124:127], v[244:247], v[84:87], v[124:127]
    v_exp_f32 v118, v118
    v_exp_f32 v119, v119
    v_mfma_f32_16x16x32_bf16 v[120:123], v[232:235], v[88:91], v[120:123]
    v_cvt_pk_f16_f32 v112, v112, v113
    v_cvt_pk_f16_f32 v113, v114, v115
    v_mfma_f32_16x16x32_bf16 v[124:127], v[248:251], v[88:91], v[124:127]
    v_cvt_pk_f16_f32 v114, v116, v117
    v_cvt_pk_f16_f32 v115, v118, v119
    v_mfma_f32_16x16x32_bf16 v[120:123], v[236:239], v[92:95], v[120:123]
    v_pk_add_f16 v112, v112, s43
    v_pk_add_f16 v113, v113, s43
    v_pk_add_f16 v114, v114, s43
    v_pk_add_f16 v115, v115, s43
    v_mfma_f32_16x16x32_bf16 v[124:127], v[252:255], v[92:95], v[124:127]
    v_rcp_f16_sdwa v112, v112 dst_sel:WORD_0 dst_unused:UNUSED_PRESERVE src0_sel:WORD_0
    v_rcp_f16_sdwa v113, v113 dst_sel:WORD_0 dst_unused:UNUSED_PRESERVE src0_sel:WORD_0
    v_rcp_f16_sdwa v114, v114 dst_sel:WORD_0 dst_unused:UNUSED_PRESERVE src0_sel:WORD_0
    v_rcp_f16_sdwa v115, v115 dst_sel:WORD_0 dst_unused:UNUSED_PRESERVE src0_sel:WORD_0
    s_sub_u32 s42, s42, 1
    s_cbranch_scc0 L_PSW_f0
    s_setprio 0
L_PSW_f0:
    s_sub_u32 s38, s38, 1
    s_cmp_eq_u32 s38, 0
    s_cbranch_scc1 L_DRAIN
    s_waitcnt vmcnt(4)
    ds_read_b128 v[96:99], v14 offset:0
    ds_read_b128 v[80:83], v20 offset:4128
    ds_read_b128 v[100:103], v14 offset:64
    ds_read_b128 v[84:87], v21 offset:4128
    ds_read_b128 v[88:91], v22 offset:4128
    ds_read_b128 v[92:95], v23 offset:4128
    ds_read_b128 v[104:107], v14 offset:128
    ds_read_b128 v[108:111], v14 offset:192
    v_exp_f32 v120, v120
    v_rcp_f16_sdwa v112, v112 dst_sel:WORD_1 dst_unused:UNUSED_PRESERVE src0_sel:WORD_1
    v_rcp_f16_sdwa v113, v113 dst_sel:WORD_1 dst_unused:UNUSED_PRESERVE src0_sel:WORD_1
    v_exp_f32 v121, v121
    v_rcp_f16_sdwa v114, v114 dst_sel:WORD_1 dst_unused:UNUSED_PRESERVE src0_sel:WORD_1
    v_rcp_f16_sdwa v115, v115 dst_sel:WORD_1 dst_unused:UNUSED_PRESERVE src0_sel:WORD_1
    v_exp_f32 v122, v122
    v_exp_f32 v123, v123
    v_mfma_f32_16x16x32_f16 v[36:39], v[112:115], v[56:59], v[36:39]
    ds_read_b128 v[112:115], v14 offset:256
    ds_read_b128 v[116:119], v14 offset:320
    v_exp_f32 v124, v124
    v_exp_f32 v125, v125
    v_exp_f32 v126, v126
    v_exp_f32 v127, v127
    v_cvt_pk_f16_f32 v120, v120, v121
    v_cvt_pk_f16_f32 v121, v122, v123
    s_branch L_BODY1
L_FIRST1:
    s_waitcnt vmcnt(4)
    ds_read_b128 v[96:99], v14 offset:0
    ds_read_b128 v[80:83], v20 offset:4128
    ds_read_b128 v[100:103], v14 offset:64
    ds_read_b128 v[84:87], v21 offset:4128
    ds_read_b128 v[88:91], v22 offset:4128
    ds_read_b128 v[92:95], v23 offset:4128
    ds_read_b128 v[104:107], v14 offset:128
    ds_read_b128 v[108:111], v14 offset:192
    ds_read_b128 v[112:115], v14 offset:256
    ds_read_b128 v[116:119], v14 offset:320
    s_waitcnt lgkmcnt(4)
    v_mfma_f32_16x16x32_bf16 v[96:99], v[128:131], v[80:83], v[96:99]
    v_mfma_f32_16x16x32_bf16 v[100:103], v[144:147], v[80:83], v[100:103]
    v_mfma_f32_16x16x32_bf16 v[96:99], v[132:135], v[84:87], v[96:99]
    v_mfma_f32_16x16x32_bf16 v[100:103], v[148:151], v[84:87], v[100:103]
    v_mfma_f32_16x16x32_bf16 v[96:99], v[136:139], v[88:91], v[96:99]
    v_mfma_f32_16x16x32_bf16 v[100:103], v[152:155], v[88:91], v[100:103]
    v_mfma_f32_16x16x32_bf16 v[96:99], v[140:143], v[92:95], v[96:99]
    v_mfma_f32_16x16x32_bf16 v[100:103], v[156:159], v[92:95], v[100:103]
    ds_read_u16 v24, v12 offset:96
    ds_read_u16 v25, v12 offset:104
    ds_read_u16 v26, v12 offset:112
    ds_read_u16 v27, v12 offset:120
    ds_read_b128 v[120:123], v14 offset:384
    ds_read_b128 v[124:127], v14 offset:448
    s_waitcnt lgkmcnt(8)
    v_mfma_f32_16x16x32_bf16 v[104:107], v[160:163], v[80:83], v[104:107]
    v_exp_f32 v96, v96
    v_exp_f32 v97, v97
    v_exp_f32 v98, v98
    v_exp_f32 v99, v99
    v_exp_f32 v100, v100
    v_exp_f32 v101, v101
    v_exp_f32 v102, v102
    ds_read_b64_tr_b16 v[64:65], v16 offset:4128
    ds_read_b64_tr_b16 v[66:67], v17 offset:4128
    ds_read_b64_tr_b16 v[68:69], v16 offset:5152
    ds_read_b64_tr_b16 v[70:71], v17 offset:5152
    ds_read_b64_tr_b16 v[72:73], v16 offset:6208
    ds_read_b64_tr_b16 v[74:75], v17 offset:6208
    ds_read_b64_tr_b16 v[76:77], v16 offset:7232
    ds_read_b64_tr_b16 v[78:79], v17 offset:7232
    ds_read_u16_d16_hi v32, v13 offset:32
    ds_read_u16_d16_hi v33, v13 offset:34
    ds_read_u16_d16_hi v34, v13 offset:36
    ds_read_u16_d16_hi v35, v13 offset:38
    v_mfma_f32_16x16x32_bf16 v[108:111], v[176:179], v[80:83], v[108:111]
    v_exp_f32 v103, v103
    v_cvt_pk_f16_f32 v96, v96, v97
    v_mfma_f32_16x16x32_bf16 v[104:107], v[164:167], v[84:87], v[104:107]
    v_cvt_pk_f16_f32 v97, v98, v99
    v_cvt_pk_f16_f32 v98, v100, v101
    v_mfma_f32_16x16x32_bf16 v[108:111], v[180:183], v[84:87], v[108:111]
    v_cvt_pk_f16_f32 v99, v102, v103
    v_pk_add_f16 v96, v96, s43
    v_mfma_f32_16x16x32_bf16 v[104:107], v[168:171], v[88:91], v[104:107]
    v_pk_add_f16 v97, v97, s43
    v_pk_add_f16 v98, v98, s43
    v_mfma_f32_16x16x32_bf16 v[108:111], v[184:187], v[88:91], v[108:111]
    v_pk_add_f16 v99, v99, s43
    v_rcp_f16_sdwa v96, v96 dst_sel:WORD_0 dst_unused:UNUSED_PRESERVE src0_sel:WORD_0
    v_mfma_f32_16x16x32_bf16 v[104:107], v[172:175], v[92:95], v[104:107]
    v_rcp_f16_sdwa v97, v97 dst_sel:WORD_0 dst_unused:UNUSED_PRESERVE src0_sel:WORD_0
    v_rcp_f16_sdwa v98, v98 dst_sel:WORD_0 dst_unused:UNUSED_PRESERVE src0_sel:WORD_0
    v_mfma_f32_16x16x32_bf16 v[108:111], v[188:191], v[92:95], v[108:111]
    s_waitcnt lgkmcnt(4)
    s_add_u32 m0, s37, 4128
    v_lshl_add_u32 v24, v24, 8, v15
    buffer_load_dwordx4 v24, s[4:7], 0 offen nt lds
    s_add_u32 m0, s37, 5152
    v_lshl_add_u32 v25, v25, 8, v15
    buffer_load_dwordx4 v25, s[4:7], 0 offen nt lds
    v_rcp_f16_sdwa v99, v99 dst_sel:WORD_0 dst_unused:UNUSED_PRESERVE src0_sel:WORD_0
    v_add_u32 v12, 64, v12
    v_mfma_f32_16x16x32_bf16 v[112:115], v[192:195], v[80:83], v[112:115]
    v_rcp_f16_sdwa v96, v96 dst_sel:WORD_1 dst_unused:UNUSED_PRESERVE src0_sel:WORD_1
    v_rcp_f16_sdwa v97, v97 dst_sel:WORD_1 dst_unused:UNUSED_PRESERVE src0_sel:WORD_1
    v_exp_f32 v104, v104
    v_mfma_f32_16x16x32_bf16 v[116:119], v[208:211], v[80:83], v[116:119]
    v_rcp_f16_sdwa v98, v98 dst_sel:WORD_1 dst_unused:UNUSED_PRESERVE src0_sel:WORD_1
    v_rcp_f16_sdwa v99, v99 dst_sel:WORD_1 dst_unused:UNUSED_PRESERVE src0_sel:WORD_1
    v_exp_f32 v105, v105
    v_mfma_f32_16x16x32_bf16 v[112:115], v[196:199], v[84:87], v[112:115]
    v_exp_f32 v106, v106
    v_exp_f32 v107, v107
    v_mfma_f32_16x16x32_f16 v[36:39], v[96:99], v[48:51], v[28:31]
    v_exp_f32 v108, v108
    v_exp_f32 v109, v109
    v_mfma_f32_16x16x32_bf16 v[116:119], v[212:215], v[84:87], v[116:119]
    v_exp_f32 v110, v110
    v_exp_f32 v111, v111
    v_mfma_f32_16x16x32_bf16 v[112:115], v[200:203], v[88:91], v[112:115]
    v_cvt_pk_f16_f32 v104, v104, v105
    v_cvt_pk_f16_f32 v105, v106, v107
    v_mfma_f32_16x16x32_bf16 v[116:119], v[216:219], v[88:91], v[116:119]
    v_cvt_pk_f16_f32 v106, v108, v109
    v_cvt_pk_f16_f32 v107, v110, v111
    v_mfma_f32_16x16x32_bf16 v[112:115], v[204:207], v[92:95], v[112:115]
    v_pk_add_f16 v104, v104, s43
    v_pk_add_f16 v105, v105, s43
    v_pk_add_f16 v106, v106, s43
    v_pk_add_f16 v107, v107, s43
    v_mfma_f32_16x16x32_bf16 v[116:119], v[220:223], v[92:95], v[116:119]
    s_add_u32 m0, s37, 6208
    v_lshl_add_u32 v26, v26, 8, v15
    buffer_load_dwordx4 v26, s[4:7], 0 offen nt lds
    s_add_u32 m0, s37, 7232
    v_lshl_add_u32 v27, v27, 8, v15
    buffer_load_dwordx4 v27, s[4:7], 0 offen nt lds
    v_rcp_f16_sdwa v104, v104 dst_sel:WORD_0 dst_unused:UNUSED_PRESERVE src0_sel:WORD_0
    v_rcp_f16_sdwa v105, v105 dst_sel:WORD_0 dst_unused:UNUSED_PRESERVE src0_sel:WORD_0
    v_rcp_f16_sdwa v106, v106 dst_sel:WORD_0 dst_unused:UNUSED_PRESERVE src0_sel:WORD_0
    v_rcp_f16_sdwa v107, v107 dst_sel:WORD_0 dst_unused:UNUSED_PRESERVE src0_sel:WORD_0
    s_waitcnt lgkmcnt(0)
    v_add_u32 v13, 64, v13
    v_mfma_f32_16x16x32_bf16 v[120:123], v[224:227], v[80:83], v[120:123]
    v_rcp_f16_sdwa v104, v104 dst_sel:WORD_1 dst_unused:UNUSED_PRESERVE src0_sel:WORD_1
    v_rcp_f16_sdwa v105, v105 dst_sel:WORD_1 dst_unused:UNUSED_PRESERVE src0_sel:WORD_1
    v_exp_f32 v112, v112
    v_mfma_f32_16x16x32_bf16 v[124:127], v[240:243], v[80:83], v[124:127]
    v_rcp_f16_sdwa v106, v106 dst_sel:WORD_1 dst_unused:UNUSED_PRESERVE src0_sel:WORD_1
    v_rcp_f16_sdwa v107, v107 dst_sel:WORD_1 dst_unused:UNUSED_PRESERVE src0_sel:WORD_1
    v_exp_f32 v113, v113
    v_mfma_f32_16x16x32_bf16 v[120:123], v[228:231], v[84:87], v[120:123]
    v_exp_f32 v114, v114
    v_exp_f32 v115, v115
    v_mfma_f32_16x16x32_f16 v[36:39], v[104:107], v[52:55], v[36:39]
    v_exp_f32 v116, v116
    v_exp_f32 v117, v117
    v_mfma_f32_16x16x32_bf16 v[124:127], v[244:247], v[84:87], v[124:127]
    v_exp_f32 v118, v118
    v_exp_f32 v119, v119
    v_mfma_f32_16x16x32_bf16 v[120:123], v[232:235], v[88:91], v[120:123]
    v_cvt_pk_f16_f32 v112, v112, v113
    v_cvt_pk_f16_f32 v113, v114, v115
    v_mfma_f32_16x16x32_bf16 v[124:127], v[248:251], v[88:91], v[124:127]
    v_cvt_pk_f16_f32 v114, v116, v117
    v_cvt_pk_f16_f32 v115, v118, v119
    v_mfma_f32_16x16x32_bf16 v[120:123], v[236:239], v[92:95], v[120:123]
    v_pk_add_f16 v112, v112, s43
    v_pk_add_f16 v113, v113, s43
    v_pk_add_f16 v114, v114, s43
    v_pk_add_f16 v115, v115, s43
    v_mfma_f32_16x16x32_bf16 v[124:127], v[252:255], v[92:95], v[124:127]
    v_rcp_f16_sdwa v112, v112 dst_sel:WORD_0 dst_unused:UNUSED_PRESERVE src0_sel:WORD_0
    v_rcp_f16_sdwa v113, v113 dst_sel:WORD_0 dst_unused:UNUSED_PRESERVE src0_sel:WORD_0
    v_rcp_f16_sdwa v114, v114 dst_sel:WORD_0 dst_unused:UNUSED_PRESERVE src0_sel:WORD_0
    v_rcp_f16_sdwa v115, v115 dst_sel:WORD_0 dst_unused:UNUSED_PRESERVE src0_sel:WORD_0
    s_sub_u32 s42, s42, 1
    s_cbranch_scc0 L_PSW_f1
    s_setprio 0
L_PSW_f1:
    s_sub_u32 s38, s38, 1
    s_cmp_eq_u32 s38, 0
    s_cbranch_scc1 L_DRAIN
    s_waitcnt vmcnt(4)
    ds_read_b128 v[96:99], v14 offset:0
    ds_read_b128 v[80:83], v20 offset:0
    ds_read_b128 v[100:103], v14 offset:64
    ds_read_b128 v[84:87], v21 offset:0
    ds_read_b128 v[88:91], v22 offset:0
    ds_read_b128 v[92:95], v23 offset:0
    ds_read_b128 v[104:107], v14 offset:128
    ds_read_b128 v[108:111], v14 offset:192
    v_exp_f32 v120, v120
    v_rcp_f16_sdwa v112, v112 dst_sel:WORD_1 dst_unused:UNUSED_PRESERVE src0_sel:WORD_1
    v_rcp_f16_sdwa v113, v113 dst_sel:WORD_1 dst_unused:UNUSED_PRESERVE src0_sel:WORD_1
    v_exp_f32 v121, v121
    v_rcp_f16_sdwa v114, v114 dst_sel:WORD_1 dst_unused:UNUSED_PRESERVE src0_sel:WORD_1
    v_rcp_f16_sdwa v115, v115 dst_sel:WORD_1 dst_unused:UNUSED_PRESERVE src0_sel:WORD_1
    v_exp_f32 v122, v122
    v_exp_f32 v123, v123
    v_mfma_f32_16x16x32_f16 v[36:39], v[112:115], v[56:59], v[36:39]
    ds_read_b128 v[112:115], v14 offset:256
    ds_read_b128 v[116:119], v14 offset:320
    v_exp_f32 v124, v124
    v_exp_f32 v125, v125
    v_exp_f32 v126, v126
    v_exp_f32 v127, v127
    v_cvt_pk_f16_f32 v120, v120, v121
    v_cvt_pk_f16_f32 v121, v122, v123
L_BODY0:
    s_waitcnt lgkmcnt(4)
    v_mfma_f32_16x16x32_bf16 v[96:99], v[128:131], v[80:83], v[96:99]
    v_cvt_pk_f16_f32 v122, v124, v125
    v_cvt_pk_f16_f32 v123, v126, v127
    v_mfma_f32_16x16x32_bf16 v[100:103], v[144:147], v[80:83], v[100:103]
    v_pk_add_f16 v120, v120, s43
    v_pk_add_f16 v121, v121, s43
    v_mfma_f32_16x16x32_bf16 v[96:99], v[132:135], v[84:87], v[96:99]
    v_pk_add_f16 v122, v122, s43
    v_pk_add_f16 v123, v123, s43
    v_mfma_f32_16x16x32_bf16 v[100:103], v[148:151], v[84:87], v[100:103]
    v_rcp_f16_sdwa v120, v120 dst_sel:WORD_0 dst_unused:UNUSED_PRESERVE src0_sel:WORD_0
    v_rcp_f16_sdwa v121, v121 dst_sel:WORD_0 dst_unused:UNUSED_PRESERVE src0_sel:WORD_0
    v_mfma_f32_16x16x32_bf16 v[96:99], v[136:139], v[88:91], v[96:99]
    v_rcp_f16_sdwa v122, v122 dst_sel:WORD_0 dst_unused:UNUSED_PRESERVE src0_sel:WORD_0
    v_rcp_f16_sdwa v123, v123 dst_sel:WORD_0 dst_unused:UNUSED_PRESERVE src0_sel:WORD_0
    v_mfma_f32_16x16x32_bf16 v[100:103], v[152:155], v[88:91], v[100:103]
    v_rcp_f16_sdwa v120, v120 dst_sel:WORD_1 dst_unused:UNUSED_PRESERVE src0_sel:WORD_1
    v_rcp_f16_sdwa v121, v121 dst_sel:WORD_1 dst_unused:UNUSED_PRESERVE src0_sel:WORD_1
    v_mfma_f32_16x16x32_bf16 v[96:99], v[140:143], v[92:95], v[96:99]
    v_rcp_f16_sdwa v122, v122 dst_sel:WORD_1 dst_unused:UNUSED_PRESERVE src0_sel:WORD_1
    v_rcp_f16_sdwa v123, v123 dst_sel:WORD_1 dst_unused:UNUSED_PRESERVE src0_sel:WORD_1
    v_mfma_f32_16x16x32_bf16 v[100:103], v[156:159], v[92:95], v[100:103]
    ds_read_u16 v24, v12 offset:64
    ds_read_u16 v25, v12 offset:72
    ds_read_u16 v26, v12 offset:80
    ds_read_u16 v27, v12 offset:88
    v_mfma_f32_16x16x32_f16 v[36:39], v[120:123], v[60:63], v[36:39]
    ds_read_b128 v[120:123], v14 offset:384
    ds_read_b128 v[124:127], v14 offset:448
    s_waitcnt lgkmcnt(8)
    v_mfma_f32_16x16x32_bf16 v[104:107], v[160:163], v[80:83], v[104:107]
    v_exp_f32 v96, v96
    v_exp_f32 v97, v97
    v_exp_f32 v98, v98
    v_exp_f32 v99, v99
    v_pk_mul_f32 v[36:37], v[36:37], v[32:33]
    v_pk_mul_f32 v[38:39], v[38:39], v[34:35]
    v_exp_f32 v100, v100
    v_cvt_pk_bf16_f32 v18, v36, v37
    v_cvt_pk_bf16_f32 v19, v38, v39
    v_exp_f32 v101, v101
    v_exp_f32 v102, v102
    v_mfma_f32_4x4x4_16b_bf16 v[40:43], v[18:19], v[64:65], v[40:43] cbsz:4 abid:0
    ds_read_b64_tr_b16 v[64:65], v16 offset:0
    v_mfma_f32_4x4x4_16b_bf16 v[44:47], v[18:19], v[66:67], v[44:47] cbsz:4 abid:0
    ds_read_b64_tr_b16 v[66:67], v17 offset:0
    v_mfma_f32_4x4x4_16b_bf16 v[40:43], v[18:19], v[68:69], v[40:43] cbsz:4 abid:4
    ds_read_b64_tr_b16 v[68:69], v16 offset:1024
    v_mfma_f32_4x4x4_16b_bf16 v[44:47], v[18:19], v[70:71], v[44:47] cbsz:4 abid:4
    ds_read_b64_tr_b16 v[70:71], v17 offset:1024
    v_mfma_f32_4x4x4_16b_bf16 v[40:43], v[18:19], v[72:73], v[40:43] cbsz:4 abid:8
    ds_read_b64_tr_b16 v[72:73], v16 offset:2080
    v_mfma_f32_4x4x4_16b_bf16 v[44:47], v[18:19], v[74:75], v[44:47] cbsz:4 abid:8
    ds_read_b64_tr_b16 v[74:75], v17 offset:2080
    v_mfma_f32_4x4x4_16b_bf16 v[40:43], v[18:19], v[76:77], v[40:43] cbsz:4 abid:12
    ds_read_b64_tr_b16 v[76:77], v16 offset:3104
    v_mfma_f32_4x4x4_16b_bf16 v[44:47], v[18:19], v[78:79], v[44:47] cbsz:4 abid:12
    ds_read_b64_tr_b16 v[78:79], v17 offset:3104
    ds_read_u16_d16_hi v32, v13 offset:0
    ds_read_u16_d16_hi v33, v13 offset:2
    ds_read_u16_d16_hi v34, v13 offset:4
    ds_read_u16_d16_hi v35, v13 offset:6
    v_mfma_f32_16x16x32_bf16 v[108:111], v[176:179], v[80:83], v[108:111]
    v_exp_f32 v103, v103
    v_cvt_pk_f16_f32 v96, v96, v97
    v_mfma_f32_16x16x32_bf16 v[104:107], v[164:167], v[84:87], v[104:107]
    v_cvt_pk_f16_f32 v97, v98, v99
    v_cvt_pk_f16_f32 v98, v100, v101
    v_mfma_f32_16x16x32_bf16 v[108:111], v[180:183], v[84:87], v[108:111]
    v_cvt_pk_f16_f32 v99, v102, v103
    v_pk_add_f16 v96, v96, s43
    v_mfma_f32_16x16x32_bf16 v[104:107], v[168:171], v[88:91], v[104:107]
    v_pk_add_f16 v97, v97, s43
    v_pk_add_f16 v98, v98, s43
    v_mfma_f32_16x16x32_bf16 v[108:111], v[184:187], v[88:91], v[108:111]
    v_pk_add_f16 v99, v99, s43
    v_rcp_f16_sdwa v96, v96 dst_sel:WORD_0 dst_unused:UNUSED_PRESERVE src0_sel:WORD_0
    v_mfma_f32_16x16x32_bf16 v[104:107], v[172:175], v[92:95], v[104:107]
    v_rcp_f16_sdwa v97, v97 dst_sel:WORD_0 dst_unused:UNUSED_PRESERVE src0_sel:WORD_0
    v_rcp_f16_sdwa v98, v98 dst_sel:WORD_0 dst_unused:UNUSED_PRESERVE src0_sel:WORD_0
    v_mfma_f32_16x16x32_bf16 v[108:111], v[188:191], v[92:95], v[108:111]
    s_waitcnt lgkmcnt(4)
    s_add_u32 m0, s37, 0
    v_lshl_add_u32 v24, v24, 8, v15
    buffer_load_dwordx4 v24, s[4:7], 0 offen nt lds
    s_add_u32 m0, s37, 1024
    v_lshl_add_u32 v25, v25, 8, v15
    buffer_load_dwordx4 v25, s[4:7], 0 offen nt lds
    v_rcp_f16_sdwa v99, v99 dst_sel:WORD_0 dst_unused:UNUSED_PRESERVE src0_sel:WORD_0
    v_mfma_f32_16x16x32_bf16 v[112:115], v[192:195], v[80:83], v[112:115]
    v_rcp_f16_sdwa v96, v96 dst_sel:WORD_1 dst_unused:UNUSED_PRESERVE src0_sel:WORD_1
    v_rcp_f16_sdwa v97, v97 dst_sel:WORD_1 dst_unused:UNUSED_PRESERVE src0_sel:WORD_1
    v_exp_f32 v104, v104
    v_mfma_f32_16x16x32_bf16 v[116:119], v[208:211], v[80:83], v[116:119]
    v_rcp_f16_sdwa v98, v98 dst_sel:WORD_1 dst_unused:UNUSED_PRESERVE src0_sel:WORD_1
    v_rcp_f16_sdwa v99, v99 dst_sel:WORD_1 dst_unused:UNUSED_PRESERVE src0_sel:WORD_1
    v_exp_f32 v105, v105
    v_mfma_f32_16x16x32_bf16 v[112:115], v[196:199], v[84:87], v[112:115]
    v_exp_f32 v106, v106
    v_exp_f32 v107, v107
    v_mfma_f32_16x16x32_f16 v[36:39], v[96:99], v[48:51], v[28:31]
    v_exp_f32 v108, v108
    v_exp_f32 v109, v109
    v_mfma_f32_16x16x32_bf16 v[116:119], v[212:215], v[84:87], v[116:119]
    v_exp_f32 v110, v110
    v_exp_f32 v111, v111
    v_mfma_f32_16x16x32_bf16 v[112:115], v[200:203], v[88:91], v[112:115]
    v_cvt_pk_f16_f32 v104, v104, v105
    v_cvt_pk_f16_f32 v105, v106, v107
    v_mfma_f32_16x16x32_bf16 v[116:119], v[216:219], v[88:91], v[116:119]
    v_cvt_pk_f16_f32 v106, v108, v109
    v_cvt_pk_f16_f32 v107, v110, v111
    v_mfma_f32_16x16x32_bf16 v[112:115], v[204:207], v[92:95], v[112:115]
    v_pk_add_f16 v104, v104, s43
    v_pk_add_f16 v105, v105, s43
    v_pk_add_f16 v106, v106, s43
    v_pk_add_f16 v107, v107, s43
    v_mfma_f32_16x16x32_bf16 v[116:119], v[220:223], v[92:95], v[116:119]
    s_add_u32 m0, s37, 2080
    v_lshl_add_u32 v26, v26, 8, v15
    buffer_load_dwordx4 v26, s[4:7], 0 offen nt lds
    s_add_u32 m0, s37, 3104
    v_lshl_add_u32 v27, v27, 8, v15
    buffer_load_dwordx4 v27, s[4:7], 0 offen nt lds
    v_rcp_f16_sdwa v104, v104 dst_sel:WORD_0 dst_unused:UNUSED_PRESERVE src0_sel:WORD_0
    v_rcp_f16_sdwa v105, v105 dst_sel:WORD_0 dst_unused:UNUSED_PRESERVE src0_sel:WORD_0
    v_rcp_f16_sdwa v106, v106 dst_sel:WORD_0 dst_unused:UNUSED_PRESERVE src0_sel:WORD_0
    v_rcp_f16_sdwa v107, v107 dst_sel:WORD_0 dst_unused:UNUSED_PRESERVE src0_sel:WORD_0
    s_waitcnt lgkmcnt(0)
    v_mfma_f32_16x16x32_bf16 v[120:123], v[224:227], v[80:83], v[120:123]
    v_rcp_f16_sdwa v104, v104 dst_sel:WORD_1 dst_unused:UNUSED_PRESERVE src0_sel:WORD_1
    v_rcp_f16_sdwa v105, v105 dst_sel:WORD_1 dst_unused:UNUSED_PRESERVE src0_sel:WORD_1
    v_exp_f32 v112, v112
    v_mfma_f32_16x16x32_bf16 v[124:127], v[240:243], v[80:83], v[124:127]
    v_rcp_f16_sdwa v106, v106 dst_sel:WORD_1 dst_unused:UNUSED_PRESERVE src0_sel:WORD_1
    v_rcp_f16_sdwa v107, v107 dst_sel:WORD_1 dst_unused:UNUSED_PRESERVE src0_sel:WORD_1
    v_exp_f32 v113, v113
    v_mfma_f32_16x16x32_bf16 v[120:123], v[228:231], v[84:87], v[120:123]
    v_exp_f32 v114, v114
    v_exp_f32 v115, v115
    v_mfma_f32_16x16x32_f16 v[36:39], v[104:107], v[52:55], v[36:39]
    v_exp_f32 v116, v116
    v_exp_f32 v117, v117
    v_mfma_f32_16x16x32_bf16 v[124:127], v[244:247], v[84:87], v[124:127]
    v_exp_f32 v118, v118
    v_exp_f32 v119, v119
    v_mfma_f32_16x16x32_bf16 v[120:123], v[232:235], v[88:91], v[120:123]
    v_cvt_pk_f16_f32 v112, v112, v113
    v_cvt_pk_f16_f32 v113, v114, v115
    v_mfma_f32_16x16x32_bf16 v[124:127], v[248:251], v[88:91], v[124:127]
    v_cvt_pk_f16_f32 v114, v116, v117
    v_cvt_pk_f16_f32 v115, v118, v119
    v_mfma_f32_16x16x32_bf16 v[120:123], v[236:239], v[92:95], v[120:123]
    v_pk_add_f16 v112, v112, s43
    v_pk_add_f16 v113, v113, s43
    v_pk_add_f16 v114, v114, s43
    v_pk_add_f16 v115, v115, s43
    v_mfma_f32_16x16x32_bf16 v[124:127], v[252:255], v[92:95], v[124:127]
    v_rcp_f16_sdwa v112, v112 dst_sel:WORD_0 dst_unused:UNUSED_PRESERVE src0_sel:WORD_0
    v_rcp_f16_sdwa v113, v113 dst_sel:WORD_0 dst_unused:UNUSED_PRESERVE src0_sel:WORD_0
    v_rcp_f16_sdwa v114, v114 dst_sel:WORD_0 dst_unused:UNUSED_PRESERVE src0_sel:WORD_0
    v_rcp_f16_sdwa v115, v115 dst_sel:WORD_0 dst_unused:UNUSED_PRESERVE src0_sel:WORD_0
    s_sub_u32 s42, s42, 1
    s_cbranch_scc0 L_PSW_b0
    s_setprio 0
L_PSW_b0:
    s_sub_u32 s38, s38, 1
    s_cmp_eq_u32 s38, 0
    s_cbranch_scc1 L_DRAIN
    s_waitcnt vmcnt(4)
    ds_read_b128 v[96:99], v14 offset:0
    ds_read_b128 v[80:83], v20 offset:4128
    ds_read_b128 v[100:103], v14 offset:64
    ds_read_b128 v[84:87], v21 offset:4128
    ds_read_b128 v[88:91], v22 offset:4128
    ds_read_b128 v[92:95], v23 offset:4128
    ds_read_b128 v[104:107], v14 offset:128
    ds_read_b128 v[108:111], v14 offset:192
    v_exp_f32 v120, v120
    v_rcp_f16_sdwa v112, v112 dst_sel:WORD_1 dst_unused:UNUSED_PRESERVE src0_sel:WORD_1
    v_rcp_f16_sdwa v113, v113 dst_sel:WORD_1 dst_unused:UNUSED_PRESERVE src0_sel:WORD_1
    v_exp_f32 v121, v121
    v_rcp_f16_sdwa v114, v114 dst_sel:WORD_1 dst_unused:UNUSED_PRESERVE src0_sel:WORD_1
    v_rcp_f16_sdwa v115, v115 dst_sel:WORD_1 dst_unused:UNUSED_PRESERVE src0_sel:WORD_1
    v_exp_f32 v122, v122
    v_exp_f32 v123, v123
    v_mfma_f32_16x16x32_f16 v[36:39], v[112:115], v[56:59], v[36:39]
    ds_read_b128 v[112:115], v14 offset:256
    ds_read_b128 v[116:119], v14 offset:320
    v_exp_f32 v124, v124
    v_exp_f32 v125, v125
    v_exp_f32 v126, v126
    v_exp_f32 v127, v127
    v_cvt_pk_f16_f32 v120, v120, v121
    v_cvt_pk_f16_f32 v121, v122, v123
L_BODY1:
    s_waitcnt lgkmcnt(4)
    v_mfma_f32_16x16x32_bf16 v[96:99], v[128:131], v[80:83], v[96:99]
    v_cvt_pk_f16_f32 v122, v124, v125
    v_cvt_pk_f16_f32 v123, v126, v127
    v_mfma_f32_16x16x32_bf16 v[100:103], v[144:147], v[80:83], v[100:103]
    v_pk_add_f16 v120, v120, s43
    v_pk_add_f16 v121, v121, s43
    v_mfma_f32_16x16x32_bf16 v[96:99], v[132:135], v[84:87], v[96:99]
    v_pk_add_f16 v122, v122, s43
    v_pk_add_f16 v123, v123, s43
    v_mfma_f32_16x16x32_bf16 v[100:103], v[148:151], v[84:87], v[100:103]
    v_rcp_f16_sdwa v120, v120 dst_sel:WORD_0 dst_unused:UNUSED_PRESERVE src0_sel:WORD_0
    v_rcp_f16_sdwa v121, v121 dst_sel:WORD_0 dst_unused:UNUSED_PRESERVE src0_sel:WORD_0
    v_mfma_f32_16x16x32_bf16 v[96:99], v[136:139], v[88:91], v[96:99]
    v_rcp_f16_sdwa v122, v122 dst_sel:WORD_0 dst_unused:UNUSED_PRESERVE src0_sel:WORD_0
    v_rcp_f16_sdwa v123, v123 dst_sel:WORD_0 dst_unused:UNUSED_PRESERVE src0_sel:WORD_0
    v_mfma_f32_16x16x32_bf16 v[100:103], v[152:155], v[88:91], v[100:103]
    v_rcp_f16_sdwa v120, v120 dst_sel:WORD_1 dst_unused:UNUSED_PRESERVE src0_sel:WORD_1
    v_rcp_f16_sdwa v121, v121 dst_sel:WORD_1 dst_unused:UNUSED_PRESERVE src0_sel:WORD_1
    v_mfma_f32_16x16x32_bf16 v[96:99], v[140:143], v[92:95], v[96:99]
    v_rcp_f16_sdwa v122, v122 dst_sel:WORD_1 dst_unused:UNUSED_PRESERVE src0_sel:WORD_1
    v_rcp_f16_sdwa v123, v123 dst_sel:WORD_1 dst_unused:UNUSED_PRESERVE src0_sel:WORD_1
    v_mfma_f32_16x16x32_bf16 v[100:103], v[156:159], v[92:95], v[100:103]
    ds_read_u16 v24, v12 offset:96
    ds_read_u16 v25, v12 offset:104
    ds_read_u16 v26, v12 offset:112
    ds_read_u16 v27, v12 offset:120
    v_mfma_f32_16x16x32_f16 v[36:39], v[120:123], v[60:63], v[36:39]
    ds_read_b128 v[120:123], v14 offset:384
    ds_read_b128 v[124:127], v14 offset:448
    s_waitcnt lgkmcnt(8)
    v_mfma_f32_16x16x32_bf16 v[104:107], v[160:163], v[80:83], v[104:107]
    v_exp_f32 v96, v96
    v_exp_f32 v97, v97
    v_exp_f32 v98, v98
    v_exp_f32 v99, v99
    v_pk_mul_f32 v[36:37], v[36:37], v[32:33]
    v_pk_mul_f32 v[38:39], v[38:39], v[34:35]
    v_exp_f32 v100, v100
    v_cvt_pk_bf16_f32 v18, v36, v37
    v_cvt_pk_bf16_f32 v19, v38, v39
    v_exp_f32 v101, v101
    v_exp_f32 v102, v102
    v_mfma_f32_4x4x4_16b_bf16 v[40:43], v[18:19], v[64:65], v[40:43] cbsz:4 abid:0
    ds_read_b64_tr_b16 v[64:65], v16 offset:4128
    v_mfma_f32_4x4x4_16b_bf16 v[44:47], v[18:19], v[66:67], v[44:47] cbsz:4 abid:0
    ds_read_b64_tr_b16 v[66:67], v17 offset:4128
    v_mfma_f32_4x4x4_16b_bf16 v[40:43], v[18:19], v[68:69], v[40:43] cbsz:4 abid:4
    ds_read_b64_tr_b16 v[68:69], v16 offset:5152
    v_mfma_f32_4x4x4_16b_bf16 v[44:47], v[18:19], v[70:71], v[44:47] cbsz:4 abid:4
    ds_read_b64_tr_b16 v[70:71], v17 offset:5152
    v_mfma_f32_4x4x4_16b_bf16 v[40:43], v[18:19], v[72:73], v[40:43] cbsz:4 abid:8
    ds_read_b64_tr_b16 v[72:73], v16 offset:6208
    v_mfma_f32_4x4x4_16b_bf16 v[44:47], v[18:19], v[74:75], v[44:47] cbsz:4 abid:8
    ds_read_b64_tr_b16 v[74:75], v17 offset:6208
    v_mfma_f32_4x4x4_16b_bf16 v[40:43], v[18:19], v[76:77], v[40:43] cbsz:4 abid:12
    ds_read_b64_tr_b16 v[76:77], v16 offset:7232
    v_mfma_f32_4x4x4_16b_bf16 v[44:47], v[18:19], v[78:79], v[44:47] cbsz:4 abid:12
    ds_read_b64_tr_b16 v[78:79], v17 offset:7232
    ds_read_u16_d16_hi v32, v13 offset:32
    ds_read_u16_d16_hi v33, v13 offset:34
    ds_read_u16_d16_hi v34, v13 offset:36
    ds_read_u16_d16_hi v35, v13 offset:38
    v_mfma_f32_16x16x32_bf16 v[108:111], v[176:179], v[80:83], v[108:111]
    v_exp_f32 v103, v103
    v_cvt_pk_f16_f32 v96, v96, v97
    v_mfma_f32_16x16x32_bf16 v[104:107], v[164:167], v[84:87], v[104:107]
    v_cvt_pk_f16_f32 v97, v98, v99
    v_cvt_pk_f16_f32 v98, v100, v101
    v_mfma_f32_16x16x32_bf16 v[108:111], v[180:183], v[84:87], v[108:111]
    v_cvt_pk_f16_f32 v99, v102, v103
    v_pk_add_f16 v96, v96, s43
    v_mfma_f32_16x16x32_bf16 v[104:107], v[168:171], v[88:91], v[104:107]
    v_pk_add_f16 v97, v97, s43
    v_pk_add_f16 v98, v98, s43
    v_mfma_f32_16x16x32_bf16 v[108:111], v[184:187], v[88:91], v[108:111]
    v_pk_add_f16 v99, v99, s43
    v_rcp_f16_sdwa v96, v96 dst_sel:WORD_0 dst_unused:UNUSED_PRESERVE src0_sel:WORD_0
    v_mfma_f32_16x16x32_bf16 v[104:107], v[172:175], v[92:95], v[104:107]
    v_rcp_f16_sdwa v97, v97 dst_sel:WORD_0 dst_unused:UNUSED_PRESERVE src0_sel:WORD_0
    v_rcp_f16_sdwa v98, v98 dst_sel:WORD_0 dst_unused:UNUSED_PRESERVE src0_sel:WORD_0
    v_mfma_f32_16x16x32_bf16 v[108:111], v[188:191], v[92:95], v[108:111]
    s_waitcnt lgkmcnt(4)
    s_add_u32 m0, s37, 4128
    v_lshl_add_u32 v24, v24, 8, v15
    buffer_load_dwordx4 v24, s[4:7], 0 offen nt lds
    s_add_u32 m0, s37, 5152
    v_lshl_add_u32 v25, v25, 8, v15
    buffer_load_dwordx4 v25, s[4:7], 0 offen nt lds
    v_rcp_f16_sdwa v99, v99 dst_sel:WORD_0 dst_unused:UNUSED_PRESERVE src0_sel:WORD_0
    v_add_u32 v12, 64, v12
    v_mfma_f32_16x16x32_bf16 v[112:115], v[192:195], v[80:83], v[112:115]
    v_rcp_f16_sdwa v96, v96 dst_sel:WORD_1 dst_unused:UNUSED_PRESERVE src0_sel:WORD_1
    v_rcp_f16_sdwa v97, v97 dst_sel:WORD_1 dst_unused:UNUSED_PRESERVE src0_sel:WORD_1
    v_exp_f32 v104, v104
    v_mfma_f32_16x16x32_bf16 v[116:119], v[208:211], v[80:83], v[116:119]
    v_rcp_f16_sdwa v98, v98 dst_sel:WORD_1 dst_unused:UNUSED_PRESERVE src0_sel:WORD_1
    v_rcp_f16_sdwa v99, v99 dst_sel:WORD_1 dst_unused:UNUSED_PRESERVE src0_sel:WORD_1
    v_exp_f32 v105, v105
    v_mfma_f32_16x16x32_bf16 v[112:115], v[196:199], v[84:87], v[112:115]
    v_exp_f32 v106, v106
    v_exp_f32 v107, v107
    v_mfma_f32_16x16x32_f16 v[36:39], v[96:99], v[48:51], v[28:31]
    v_exp_f32 v108, v108
    v_exp_f32 v109, v109
    v_mfma_f32_16x16x32_bf16 v[116:119], v[212:215], v[84:87], v[116:119]
    v_exp_f32 v110, v110
    v_exp_f32 v111, v111
    v_mfma_f32_16x16x32_bf16 v[112:115], v[200:203], v[88:91], v[112:115]
    v_cvt_pk_f16_f32 v104, v104, v105
    v_cvt_pk_f16_f32 v105, v106, v107
    v_mfma_f32_16x16x32_bf16 v[116:119], v[216:219], v[88:91], v[116:119]
    v_cvt_pk_f16_f32 v106, v108, v109
    v_cvt_pk_f16_f32 v107, v110, v111
    v_mfma_f32_16x16x32_bf16 v[112:115], v[204:207], v[92:95], v[112:115]
    v_pk_add_f16 v104, v104, s43
    v_pk_add_f16 v105, v105, s43
    v_pk_add_f16 v106, v106, s43
    v_pk_add_f16 v107, v107, s43
    v_mfma_f32_16x16x32_bf16 v[116:119], v[220:223], v[92:95], v[116:119]
    s_add_u32 m0, s37, 6208
    v_lshl_add_u32 v26, v26, 8, v15
    buffer_load_dwordx4 v26, s[4:7], 0 offen nt lds
    s_add_u32 m0, s37, 7232
    v_lshl_add_u32 v27, v27, 8, v15
    buffer_load_dwordx4 v27, s[4:7], 0 offen nt lds
    v_rcp_f16_sdwa v104, v104 dst_sel:WORD_0 dst_unused:UNUSED_PRESERVE src0_sel:WORD_0
    v_rcp_f16_sdwa v105, v105 dst_sel:WORD_0 dst_unused:UNUSED_PRESERVE src0_sel:WORD_0
    v_rcp_f16_sdwa v106, v106 dst_sel:WORD_0 dst_unused:UNUSED_PRESERVE src0_sel:WORD_0
    v_rcp_f16_sdwa v107, v107 dst_sel:WORD_0 dst_unused:UNUSED_PRESERVE src0_sel:WORD_0
    s_waitcnt lgkmcnt(0)
    v_add_u32 v13, 64, v13
    v_mfma_f32_16x16x32_bf16 v[120:123], v[224:227], v[80:83], v[120:123]
    v_rcp_f16_sdwa v104, v104 dst_sel:WORD_1 dst_unused:UNUSED_PRESERVE src0_sel:WORD_1
    v_rcp_f16_sdwa v105, v105 dst_sel:WORD_1 dst_unused:UNUSED_PRESERVE src0_sel:WORD_1
    v_exp_f32 v112, v112
    v_mfma_f32_16x16x32_bf16 v[124:127], v[240:243], v[80:83], v[124:127]
    v_rcp_f16_sdwa v106, v106 dst_sel:WORD_1 dst_unused:UNUSED_PRESERVE src0_sel:WORD_1
    v_rcp_f16_sdwa v107, v107 dst_sel:WORD_1 dst_unused:UNUSED_PRESERVE src0_sel:WORD_1
    v_exp_f32 v113, v113
    v_mfma_f32_16x16x32_bf16 v[120:123], v[228:231], v[84:87], v[120:123]
    v_exp_f32 v114, v114
    v_exp_f32 v115, v115
    v_mfma_f32_16x16x32_f16 v[36:39], v[104:107], v[52:55], v[36:39]
    v_exp_f32 v116, v116
    v_exp_f32 v117, v117
    v_mfma_f32_16x16x32_bf16 v[124:127], v[244:247], v[84:87], v[124:127]
    v_exp_f32 v118, v118
    v_exp_f32 v119, v119
    v_mfma_f32_16x16x32_bf16 v[120:123], v[232:235], v[88:91], v[120:123]
    v_cvt_pk_f16_f32 v112, v112, v113
    v_cvt_pk_f16_f32 v113, v114, v115
    v_mfma_f32_16x16x32_bf16 v[124:127], v[248:251], v[88:91], v[124:127]
    v_cvt_pk_f16_f32 v114, v116, v117
    v_cvt_pk_f16_f32 v115, v118, v119
    v_mfma_f32_16x16x32_bf16 v[120:123], v[236:239], v[92:95], v[120:123]
    v_pk_add_f16 v112, v112, s43
    v_pk_add_f16 v113, v113, s43
    v_pk_add_f16 v114, v114, s43
    v_pk_add_f16 v115, v115, s43
    v_mfma_f32_16x16x32_bf16 v[124:127], v[252:255], v[92:95], v[124:127]
    v_rcp_f16_sdwa v112, v112 dst_sel:WORD_0 dst_unused:UNUSED_PRESERVE src0_sel:WORD_0
    v_rcp_f16_sdwa v113, v113 dst_sel:WORD_0 dst_unused:UNUSED_PRESERVE src0_sel:WORD_0
    v_rcp_f16_sdwa v114, v114 dst_sel:WORD_0 dst_unused:UNUSED_PRESERVE src0_sel:WORD_0
    v_rcp_f16_sdwa v115, v115 dst_sel:WORD_0 dst_unused:UNUSED_PRESERVE src0_sel:WORD_0
    s_sub_u32 s42, s42, 1
    s_cbranch_scc0 L_PSW_b1
    s_setprio 0
L_PSW_b1:
    s_sub_u32 s38, s38, 1
    s_cmp_eq_u32 s38, 0
    s_cbranch_scc1 L_DRAIN
    s_waitcnt vmcnt(4)
    ds_read_b128 v[96:99], v14 offset:0
    ds_read_b128 v[80:83], v20 offset:0
    ds_read_b128 v[100:103], v14 offset:64
    ds_read_b128 v[84:87], v21 offset:0
    ds_read_b128 v[88:91], v22 offset:0
    ds_read_b128 v[92:95], v23 offset:0
    ds_read_b128 v[104:107], v14 offset:128
    ds_read_b128 v[108:111], v14 offset:192
    v_exp_f32 v120, v120
    v_rcp_f16_sdwa v112, v112 dst_sel:WORD_1 dst_unused:UNUSED_PRESERVE src0_sel:WORD_1
    v_rcp_f16_sdwa v113, v113 dst_sel:WORD_1 dst_unused:UNUSED_PRESERVE src0_sel:WORD_1
    v_exp_f32 v121, v121
    v_rcp_f16_sdwa v114, v114 dst_sel:WORD_1 dst_unused:UNUSED_PRESERVE src0_sel:WORD_1
    v_rcp_f16_sdwa v115, v115 dst_sel:WORD_1 dst_unused:UNUSED_PRESERVE src0_sel:WORD_1
    v_exp_f32 v122, v122
    v_exp_f32 v123, v123
    v_mfma_f32_16x16x32_f16 v[36:39], v[112:115], v[56:59], v[36:39]
    ds_read_b128 v[112:115], v14 offset:256
    ds_read_b128 v[116:119], v14 offset:320
    v_exp_f32 v124, v124
    v_exp_f32 v125, v125
    v_exp_f32 v126, v126
    v_exp_f32 v127, v127
    v_cvt_pk_f16_f32 v120, v120, v121
    v_cvt_pk_f16_f32 v121, v122, v123
    s_branch L_BODY0
L_DRAIN:
    v_rcp_f16_sdwa v112, v112 dst_sel:WORD_1 dst_unused:UNUSED_PRESERVE src0_sel:WORD_1
    v_rcp_f16_sdwa v113, v113 dst_sel:WORD_1 dst_unused:UNUSED_PRESERVE src0_sel:WORD_1
    v_rcp_f16_sdwa v114, v114 dst_sel:WORD_1 dst_unused:UNUSED_PRESERVE src0_sel:WORD_1
    v_rcp_f16_sdwa v115, v115 dst_sel:WORD_1 dst_unused:UNUSED_PRESERVE src0_sel:WORD_1
    v_exp_f32 v120, v120
    v_exp_f32 v121, v121
    v_mfma_f32_16x16x32_f16 v[36:39], v[112:115], v[56:59], v[36:39]
    v_exp_f32 v122, v122
    v_exp_f32 v123, v123
    v_exp_f32 v124, v124
    v_exp_f32 v125, v125
    v_exp_f32 v126, v126
    v_exp_f32 v127, v127
    v_cvt_pk_f16_f32 v120, v120, v121
    v_cvt_pk_f16_f32 v121, v122, v123
    v_cvt_pk_f16_f32 v122, v124, v125
    v_cvt_pk_f16_f32 v123, v126, v127
    v_pk_add_f16 v120, v120, s43
    v_pk_add_f16 v121, v121, s43
    v_pk_add_f16 v122, v122, s43
    v_pk_add_f16 v123, v123, s43
    v_rcp_f16_sdwa v120, v120 dst_sel:WORD_0 dst_unused:UNUSED_PRESERVE src0_sel:WORD_0
    v_rcp_f16_sdwa v121, v121 dst_sel:WORD_0 dst_unused:UNUSED_PRESERVE src0_sel:WORD_0
    v_rcp_f16_sdwa v122, v122 dst_sel:WORD_0 dst_unused:UNUSED_PRESERVE src0_sel:WORD_0
    v_rcp_f16_sdwa v123, v123 dst_sel:WORD_0 dst_unused:UNUSED_PRESERVE src0_sel:WORD_0
    v_rcp_f16_sdwa v120, v120 dst_sel:WORD_1 dst_unused:UNUSED_PRESERVE src0_sel:WORD_1
    v_rcp_f16_sdwa v121, v121 dst_sel:WORD_1 dst_unused:UNUSED_PRESERVE src0_sel:WORD_1
    v_rcp_f16_sdwa v122, v122 dst_sel:WORD_1 dst_unused:UNUSED_PRESERVE src0_sel:WORD_1
    v_rcp_f16_sdwa v123, v123 dst_sel:WORD_1 dst_unused:UNUSED_PRESERVE src0_sel:WORD_1
    s_nop 1
    v_mfma_f32_16x16x32_f16 v[36:39], v[120:123], v[60:63], v[36:39]
    s_nop 7
    v_pk_mul_f32 v[36:37], v[36:37], v[32:33]
    v_pk_mul_f32 v[38:39], v[38:39], v[34:35]
    v_cvt_pk_bf16_f32 v18, v36, v37
    v_cvt_pk_bf16_f32 v19, v38, v39
    s_nop 1
    v_mfma_f32_4x4x4_16b_bf16 v[40:43], v[18:19], v[64:65], v[40:43] cbsz:4 abid:0
    v_mfma_f32_4x4x4_16b_bf16 v[44:47], v[18:19], v[66:67], v[44:47] cbsz:4 abid:0
    s_nop 0
    v_mfma_f32_4x4x4_16b_bf16 v[40:43], v[18:19], v[68:69], v[40:43] cbsz:4 abid:4
    v_mfma_f32_4x4x4_16b_bf16 v[44:47], v[18:19], v[70:71], v[44:47] cbsz:4 abid:4
    s_nop 0
    v_mfma_f32_4x4x4_16b_bf16 v[40:43], v[18:19], v[72:73], v[40:43] cbsz:4 abid:8
    v_mfma_f32_4x4x4_16b_bf16 v[44:47], v[18:19], v[74:75], v[44:47] cbsz:4 abid:8
    s_nop 0
    v_mfma_f32_4x4x4_16b_bf16 v[40:43], v[18:19], v[76:77], v[40:43] cbsz:4 abid:12
    v_mfma_f32_4x4x4_16b_bf16 v[44:47], v[18:19], v[78:79], v[44:47] cbsz:4 abid:12
    s_nop 3
    v_mul_f32 v1, s45, v40
    v_mul_f32 v2, s45, v44
    v_cvt_pk_bf16_f32 v1, v1, v2
    s_lshl_b32 s46, s41, 8
    buffer_store_short v1, v3, s[32:35], s46 offen
    buffer_store_short_d16_hi v1, v3, s[32:35], s46 offen offset:128
    s_cmp_eq_u32 s41, 1
    s_cbranch_scc1 L_FIN
    s_mov_b32 s41, 1
    s_mov_b32 s38, s40
    v_add_u32 v14, 528, v14
    v_mov_b32 v36, v8
    v_mov_b32 v37, v9
    v_mov_b32 v38, v10
    v_mov_b32 v39, v11
    s_branch L_BUILD
L_FIN:
L_END:
    s_endpgm
.section .rodata,"a"
.p2align 6
.amdhsa_kernel standalone__sequential_behavior_din__recsys_kernel
  .amdhsa_next_free_vgpr 256
  .amdhsa_next_free_sgpr 102
  .amdhsa_accum_offset 256
  .amdhsa_group_segment_fixed_size 0
  .amdhsa_kernarg_size 80
  .amdhsa_user_sgpr_count 2
  .amdhsa_user_sgpr_kernarg_segment_ptr 1
  .amdhsa_system_sgpr_workgroup_id_x 1
.end_amdhsa_kernel
```
